```python
import torch

def _softmax(x, axis=-1):
    return torch.softmax(x, dim=axis)
def _gelu(x):
    return torch.nn.functional.gelu(x, approximate="tanh")
def _silu(x):
    return torch.nn.functional.silu(x)
def _sigmoid(x):
    return torch.sigmoid(x)
def _layernorm(x, axis=-1, eps=1e-5):
    m = x.mean(dim=axis, keepdim=True)
    v = x.var(dim=axis, keepdim=True, unbiased=False)
    return (x - m) / torch.sqrt(v + eps)
def _scatter_add(tgt, idx, src, axis=0):
    return tgt.clone().index_add_(axis, idx, src)
def _segment_sum(src, seg, n):
    out = torch.zeros((n,) + src.shape[1:], dtype=src.dtype)
    return out.index_add_(0, seg, src)
def _pad(x, pw):
    flat = tuple(v for pair in reversed(pw) for v in pair)
    return torch.nn.functional.pad(x, flat)

kernel_name = 'recurrent_scan__grouped_kv_mqa__glu_gated_reglu__prompt'

def setup_inputs():

    _w = (lambda a: (lambda t: t.to(torch.bfloat16) if t.is_floating_point() else t)(torch.as_tensor(a)))
    def _A_setup():
        B, S, D, H = 1, 2048, 448, 16
        Dh = D // H
        return {
            "x": _w((lambda *s: torch.randn(*s, dtype=torch.bfloat16) * 0.05)(B, S, D)),
            "wq": _w((lambda *s: torch.randn(*s, dtype=torch.bfloat16) * 0.2)(D, H * Dh)),
            "wk": _w((lambda *s: torch.randn(*s, dtype=torch.bfloat16) * 0.2)(D, Dh)),
            "wv": _w((lambda *s: torch.randn(*s, dtype=torch.bfloat16) * 0.2)(D, Dh)),
            "wo": _w((lambda *s: torch.randn(*s, dtype=torch.bfloat16) * 0.2)(H * Dh, D)),
        }
    _A_in = _A_setup()

    def _B_setup():
        B, S, D, F = 1, 2048, 448, 1792
        return {
            "x": _w((lambda *s: torch.randn(*s, dtype=torch.bfloat16) * 0.05)(B, S, D)),
            "W_gate": _w((lambda *s: torch.randn(*s, dtype=torch.bfloat16) * 0.1)(D, F) * (2.0 / D) ** 0.5),
            "W_up": _w((lambda *s: torch.randn(*s, dtype=torch.bfloat16) * 0.1)(D, F) * (2.0 / D) ** 0.5),
            "W_down": _w((lambda *s: torch.randn(*s, dtype=torch.bfloat16) * 0.1)(F, D) * (1.0 / F) ** 0.5),
        }
    _B_in = _B_setup()

    return {
        "A_x": _A_in["x"],
        "A_wq": _A_in["wq"],
        "A_wk": _A_in["wk"],
        "A_wv": _A_in["wv"],
        "A_wo": _A_in["wo"],
        "B_x": _B_in["x"],
        "B_W_gate": _B_in["W_gate"],
        "B_W_up": _B_in["W_up"],
        "B_W_down": _B_in["W_down"],
    }

def reference(A_x, A_wq, A_wk, A_wv, A_wo, B_x, B_W_gate, B_W_up, B_W_down):
    def _A_ref(x, wq, wk, wv, wo):
        B, S, D = x.shape
        H = 16
        Dh = D // H
        q = (lambda x, *d: x.permute(*d))((x @ wq).reshape(B, S, H, Dh), 0, 2, 1, 3)
        k = x @ wk
        v = x @ wv
        scores = torch.einsum("bhqd,bkd->bhqk", q, k) * (Dh ** -0.5)
        p = _softmax(scores, axis=-1)
        o = torch.einsum("bhqk,bkd->bhqd", p, v)
        return (lambda x, *d: x.permute(*d))(o, 0, 2, 1, 3).reshape(B, S, H * Dh) @ wo

    def _B_ref(x, W_gate, W_up, W_down):
        gate = torch.einsum("bsd,df->bsf", x, W_gate)
        up = torch.einsum("bsd,df->bsf", x, W_up)
        gate = gate * (lambda x, dt: x.to(dt))(gate > 0, gate.dtype)
        h = gate * up
        return torch.einsum("bsf,fd->bsd", h, W_down)

    x = A_x
    xn = _layernorm(x, axis=-1)
    s = _A_ref(xn, A_wq, A_wk, A_wv, A_wo)
    g = _silu(_B_ref(xn, B_W_gate, B_W_up, B_W_down))
    return x + s * g
```

```asm
; @launch grid=(256,1,1) block=(512,1,1) lds=163840
.amdgcn_target "amdgcn-amd-amdhsa--gfx950"
.text
.globl recurrent_scan__grouped_kv_mqa__glu_gated_reglu__prompt_kernel
.p2align 8
.type recurrent_scan__grouped_kv_mqa__glu_gated_reglu__prompt_kernel,@function
recurrent_scan__grouped_kv_mqa__glu_gated_reglu__prompt_kernel:
  s_cmp_ge_u32 s2, 256
  s_cbranch_scc1 L_end
  s_load_dwordx16 s[4:19], s[0:1], 0
  s_load_dwordx8 s[20:27], s[0:1], 64
  v_lshrrev_b32 v1, 6, v0
  s_and_b32 s31, s2, 7
  s_lshr_b32 s32, s2, 3
  s_and_b32 s28, s31, 1
  s_lshl_b32 s28, s28, 3
  s_and_b32 s33, s32, 7
  s_add_u32 s28, s28, s33
  s_lshr_b32 s29, s31, 1
  s_lshr_b32 s33, s32, 3
  s_lshl_b32 s33, s33, 2
  s_add_u32 s29, s29, s33
  v_readfirstlane_b32 s30, v1
  v_and_b32 v1, 63, v0
  s_nop 3
  s_or_b32 s32, s2, s30
  s_cmp_lg_u32 s32, 0
  s_cbranch_scc1 L_p1c_nononce
  s_memrealtime s[36:37]
  v_lshlrev_b32 v17, 7, v1
  s_waitcnt lgkmcnt(0)
  s_or_b32 s32, s36, 1
  v_mov_b32 v18, s32
  s_mov_b64 exec, 3
  global_store_dword v17, v18, s[24:25] sc1
  s_mov_b64 exec, -1
L_p1c_nononce:
L_pc0:
  s_cmp_lt_u32 s30, 4
  s_cbranch_scc1 L_compute
  s_sub_u32 s34, s30, 4
  s_and_b32 s64, s34, 1
  s_lshr_b32 s65, s34, 1
  s_mov_b32 s62, 0xffff0000
  s_mov_b32 s66, 0
  v_lshrrev_b32 v32, 3, v1
  v_and_b32 v38, 7, v1
  v_lshrrev_b32 v34, 1, v32
  v_xor_b32 v33, v38, v34
  v_mul_u32_u24 v4, 896, v32
  v_lshl_add_u32 v4, v33, 4, v4
  v_xor_b32 v5, 64, v4
  s_lshl_b32 s31, s28, 7
  s_lshl_b32 s61, s34, 5
  s_add_u32 s31, s31, s61
  s_mul_i32 s31, s31, 896
  s_waitcnt lgkmcnt(0)
  s_add_u32 s44, s4, s31
  s_addc_u32 s45, s5, 0
  s_and_b32 s45, s45, 0xffff
  s_mov_b32 s46, 28672
  s_mov_b32 s47, 0x00020000
  s_lshl_b32 s61, s34, 12
  s_add_u32 m0, s61, 0
  s_movk_i32 s31, 0
  buffer_load_dwordx4 v4, s[44:47], s31 offen lds
  s_add_u32 m0, s61, 1024
  s_movk_i32 s31, 7168
  buffer_load_dwordx4 v5, s[44:47], s31 offen lds
  s_add_u32 m0, s61, 2048
  s_movk_i32 s31, 14336
  buffer_load_dwordx4 v4, s[44:47], s31 offen lds
  s_add_u32 m0, s61, 3072
  s_movk_i32 s31, 21504
  buffer_load_dwordx4 v5, s[44:47], s31 offen lds
  s_lshl_b32 s31, s65, 3
  v_add_u32 v39, s31, v32
  v_bfe_u32 v33, v1, 1, 2
  v_and_b32 v34, 1, v1
  v_bfe_u32 v35, v1, 4, 1
  s_lshl_b32 s31, s64, 1
  v_add_u32 v36, s31, v35
  v_xor_b32 v36, v36, v33
  v_mul_u32_u24 v3, 3584, v39
  v_lshl_add_u32 v3, v36, 5, v3
  v_lshl_add_u32 v3, v34, 4, v3
  s_cmp_eq_u32 s64, 0
  s_cselect_b32 s40, s16, s18
  s_cselect_b32 s41, s17, s19
  s_and_b32 s41, s41, 0xffff
  s_mov_b32 s42, 1605632
  s_mov_b32 s43, 0x00020000
  s_mov_b32 s39, 0x00020000
  s_cmp_lt_u32 s29, 4
  s_cbranch_scc1 L_p1h_q
  s_mov_b32 s36, s40
  s_mov_b32 s37, s41
  s_mov_b32 s38, s42
  v_mov_b32 v2, v3
  s_sub_u32 s59, s29, 4
  s_lshl_b32 s59, s59, 7
  s_mov_b32 s60, 57344
  s_branch L_p1h_go
L_p1h_q:
  s_lshl_b32 s31, s29, 1
  s_add_u32 s31, s31, s64
  s_cmp_eq_u32 s31, 7
  s_cbranch_scc1 L_p1h_kv
  v_lshlrev_b32 v36, 1, v35
  v_xor_b32 v36, v36, v33
  v_mul_u32_u24 v2, 896, v39
  v_lshl_add_u32 v2, v36, 5, v2
  v_lshl_add_u32 v2, v34, 4, v2
  s_mov_b32 s36, s6
  s_and_b32 s37, s7, 0xffff
  s_mov_b32 s38, 401408
  s_lshl_b32 s59, s31, 7
  s_movk_i32 s60, 14336
  s_branch L_p1h_go
L_p1h_kv:
  v_lshrrev_b32 v36, 2, v1
  v_mul_u32_u24 v2, 56, v36
  v_and_b32 v33, 3, v1
  v_lshlrev_b32 v34, 4, v33
  v_min_u32 v34, 40, v34
  v_add_u32 v2, v2, v34
  s_cmp_eq_u32 s65, 0
  s_cselect_b32 s36, s8, s10
  s_cselect_b32 s37, s9, s11
  s_cselect_b32 s66, 1, 0
  s_and_b32 s37, s37, 0xffff
  s_mov_b32 s38, 25088
  s_mov_b32 s59, 0
  s_movk_i32 s60, 896
L_p1h_go:
  s_lshl_b32 s56, s34, 10
  s_add_u32 s56, s56, 114688
  s_add_u32 m0, s56, 0
  s_nop 0
  buffer_load_dwordx4 v2, s[36:39], s59 offen lds
  s_add_u32 s59, s59, s60
  s_add_u32 m0, s56, 4096
  s_nop 0
  buffer_load_dwordx4 v2, s[36:39], s59 offen lds
  s_add_u32 s59, s59, s60
  s_add_u32 m0, s56, 8192
  s_nop 0
  buffer_load_dwordx4 v2, s[36:39], s59 offen lds
  s_add_u32 s59, s59, s60
  s_add_u32 m0, s56, 12288
  s_nop 0
  buffer_load_dwordx4 v2, s[36:39], s59 offen lds
  s_add_u32 s59, s59, s60
  s_add_u32 m0, s61, 16384
  s_movk_i32 s31, 128
  buffer_load_dwordx4 v4, s[44:47], s31 offen lds
  s_add_u32 m0, s61, 17408
  s_movk_i32 s31, 7296
  buffer_load_dwordx4 v5, s[44:47], s31 offen lds
  s_add_u32 m0, s61, 18432
  s_movk_i32 s31, 14464
  buffer_load_dwordx4 v4, s[44:47], s31 offen lds
  s_add_u32 m0, s61, 19456
  s_movk_i32 s31, 21632
  buffer_load_dwordx4 v5, s[44:47], s31 offen lds
  s_add_u32 m0, s56, 16384
  s_nop 0
  buffer_load_dwordx4 v2, s[36:39], s59 offen lds
  s_add_u32 s59, s59, s60
  s_add_u32 m0, s56, 20480
  s_nop 0
  buffer_load_dwordx4 v2, s[36:39], s59 offen lds
  s_add_u32 s59, s59, s60
  s_add_u32 m0, s56, 24576
  s_nop 0
  buffer_load_dwordx4 v2, s[36:39], s59 offen lds
  s_add_u32 s59, s59, s60
  s_add_u32 m0, s56, 28672
  s_nop 0
  buffer_load_dwordx4 v2, s[36:39], s59 offen lds
  s_add_u32 s59, s59, s60
  s_add_u32 m0, s61, 32768
  s_movk_i32 s31, 256
  buffer_load_dwordx4 v4, s[44:47], s31 offen lds
  s_add_u32 m0, s61, 33792
  s_movk_i32 s31, 7424
  buffer_load_dwordx4 v5, s[44:47], s31 offen lds
  s_add_u32 m0, s61, 34816
  s_movk_i32 s31, 14592
  buffer_load_dwordx4 v4, s[44:47], s31 offen lds
  s_add_u32 m0, s61, 35840
  s_movk_i32 s31, 21760
  buffer_load_dwordx4 v5, s[44:47], s31 offen lds
  s_add_u32 m0, s56, 32768
  s_nop 0
  buffer_load_dwordx4 v2, s[36:39], s59 offen lds
  s_add_u32 s59, s59, s60
  s_add_u32 m0, s56, 36864
  s_nop 0
  buffer_load_dwordx4 v2, s[36:39], s59 offen lds
  s_add_u32 s59, s59, s60
  s_add_u32 m0, s56, 40960
  s_nop 0
  buffer_load_dwordx4 v2, s[36:39], s59 offen lds
  s_add_u32 s59, s59, s60
  s_add_u32 m0, s56, 45056
  s_nop 0
  buffer_load_dwordx4 v2, s[36:39], s59 offen lds
  s_add_u32 s59, s59, s60
  s_bfe_u32 s31, s2, 0x10003
  s_lshl_b32 s31, s31, 7
  v_mov_b32 v30, s31
  v_mov_b32 v31, 98304
  v_mov_b32 v29, 0
  s_waitcnt vmcnt(16)
  s_cmp_lg_u32 s34, 3
  s_cbranch_scc1 L_p1h_non
  global_load_dword v29, v30, s[24:25] sc1
L_p1h_non:
  s_barrier
  s_add_u32 m0, s61, 49152
  s_movk_i32 s31, 384
  buffer_load_dwordx4 v4, s[44:47], s31 offen lds
  s_add_u32 m0, s61, 50176
  s_movk_i32 s31, 7552
  buffer_load_dwordx4 v5, s[44:47], s31 offen lds
  s_add_u32 m0, s61, 51200
  s_movk_i32 s31, 14720
  buffer_load_dwordx4 v4, s[44:47], s31 offen lds
  s_add_u32 m0, s61, 52224
  s_movk_i32 s31, 21888
  buffer_load_dwordx4 v5, s[44:47], s31 offen lds
  s_add_u32 m0, s61, 65536
  s_movk_i32 s31, 512
  buffer_load_dwordx4 v4, s[44:47], s31 offen lds
  s_add_u32 m0, s61, 66560
  s_movk_i32 s31, 7680
  buffer_load_dwordx4 v5, s[44:47], s31 offen lds
  s_add_u32 m0, s61, 67584
  s_movk_i32 s31, 14848
  buffer_load_dwordx4 v4, s[44:47], s31 offen lds
  s_add_u32 m0, s61, 68608
  s_movk_i32 s31, 22016
  buffer_load_dwordx4 v5, s[44:47], s31 offen lds
  s_waitcnt vmcnt(16)
  s_barrier
  s_add_u32 m0, s56, 0
  s_nop 0
  buffer_load_dwordx4 v2, s[36:39], s59 offen lds
  s_add_u32 s59, s59, s60
  s_add_u32 m0, s56, 4096
  s_nop 0
  buffer_load_dwordx4 v2, s[36:39], s59 offen lds
  s_add_u32 s59, s59, s60
  s_add_u32 m0, s56, 8192
  s_nop 0
  buffer_load_dwordx4 v2, s[36:39], s59 offen lds
  s_add_u32 s59, s59, s60
  s_add_u32 m0, s56, 12288
  s_nop 0
  buffer_load_dwordx4 v2, s[36:39], s59 offen lds
  s_add_u32 s59, s59, s60
  s_add_u32 m0, s61, 81920
  s_movk_i32 s31, 640
  buffer_load_dwordx4 v4, s[44:47], s31 offen lds
  s_add_u32 m0, s61, 82944
  s_movk_i32 s31, 7808
  buffer_load_dwordx4 v5, s[44:47], s31 offen lds
  s_add_u32 m0, s61, 83968
  s_movk_i32 s31, 14976
  buffer_load_dwordx4 v4, s[44:47], s31 offen lds
  s_add_u32 m0, s61, 84992
  s_movk_i32 s31, 22144
  buffer_load_dwordx4 v5, s[44:47], s31 offen lds
  s_waitcnt vmcnt(16)
  s_waitcnt vmcnt(12)
  s_cmp_lg_u32 s34, 3
  s_cbranch_scc1 L_p1h_nopub
  s_mov_b32 s32, 200000
L_p1h_nonce:
  v_readfirstlane_b32 s35, v29
  s_sub_u32 s32, s32, 1
  s_cmp_eq_u32 s32, 0
  s_cbranch_scc1 L_p1h_nonced
  s_cmp_lg_u32 s35, 0
  s_cbranch_scc1 L_p1h_nonced
  s_sleep 2
  global_load_dword v29, v30, s[24:25] sc1
  s_waitcnt vmcnt(0)
  s_branch L_p1h_nonce
L_p1h_nonced:
  ds_write_b32 v31, v29
  s_waitcnt lgkmcnt(0)
L_p1h_nopub:
  s_barrier
  ds_read_b32 v29, v31
  s_waitcnt lgkmcnt(0)
  v_readfirstlane_b32 s35, v29
  s_add_u32 m0, s56, 16384
  s_nop 0
  buffer_load_dwordx4 v2, s[36:39], s59 offen lds
  s_add_u32 s59, s59, s60
  s_add_u32 m0, s56, 20480
  s_nop 0
  buffer_load_dwordx4 v2, s[36:39], s59 offen lds
  s_add_u32 s59, s59, s60
  s_add_u32 m0, s56, 24576
  s_nop 0
  buffer_load_dwordx4 v2, s[36:39], s59 offen lds
  s_add_u32 s59, s59, s60
  s_add_u32 m0, s56, 28672
  s_nop 0
  buffer_load_dwordx4 v2, s[36:39], s59 offen lds
  s_add_u32 s59, s59, s60
  s_waitcnt vmcnt(8)
  s_barrier
  s_add_u32 m0, s56, 32768
  s_nop 0
  buffer_load_dwordx4 v2, s[36:39], s59 offen lds
  s_add_u32 s59, s59, s60
  s_add_u32 m0, s56, 36864
  s_nop 0
  buffer_load_dwordx4 v2, s[36:39], s59 offen lds
  s_add_u32 s59, s59, s60
  s_add_u32 m0, s56, 40960
  s_nop 0
  buffer_load_dwordx4 v2, s[36:39], s59 offen lds
  s_add_u32 s59, s59, s60
  s_add_u32 m0, s56, 45056
  s_nop 0
  buffer_load_dwordx4 v2, s[36:39], s59 offen lds
  s_add_u32 s59, s59, s60
  s_add_u32 m0, s61, 98304
  s_movk_i32 s31, 768
  buffer_load_dwordx4 v4, s[44:47], s31 offen lds
  s_add_u32 m0, s61, 99328
  s_movk_i32 s31, 7936
  buffer_load_dwordx4 v5, s[44:47], s31 offen lds
  s_add_u32 m0, s61, 100352
  s_movk_i32 s31, 15104
  buffer_load_dwordx4 v4, s[44:47], s31 offen lds
  s_add_u32 m0, s61, 101376
  s_movk_i32 s31, 22272
  buffer_load_dwordx4 v5, s[44:47], s31 offen lds
  s_waitcnt vmcnt(8)
  s_barrier
  s_add_u32 m0, s56, 0
  s_nop 0
  buffer_load_dwordx4 v2, s[36:39], s59 offen lds
  s_add_u32 s59, s59, s60
  s_add_u32 m0, s56, 4096
  s_nop 0
  buffer_load_dwordx4 v2, s[36:39], s59 offen lds
  s_add_u32 s59, s59, s60
  s_add_u32 m0, s56, 8192
  s_nop 0
  buffer_load_dwordx4 v2, s[36:39], s59 offen lds
  s_add_u32 s59, s59, s60
  s_add_u32 m0, s56, 12288
  s_nop 0
  buffer_load_dwordx4 v2, s[36:39], s59 offen lds
  s_add_u32 s59, s59, s60
  s_waitcnt vmcnt(8)
  s_barrier
  v_mov_b32 v2, v3
  s_mov_b32 s36, s40
  s_mov_b32 s37, s41
  s_mov_b32 s38, s42
  s_add_u32 s59, s29, 12
  s_lshl_b32 s59, s59, 7
  s_mov_b32 s60, 57344
  s_add_u32 m0, s56, 16384
  s_nop 0
  buffer_load_dwordx4 v2, s[36:39], s59 offen lds
  s_add_u32 s59, s59, s60
  s_add_u32 m0, s56, 20480
  s_nop 0
  buffer_load_dwordx4 v2, s[36:39], s59 offen lds
  s_add_u32 s59, s59, s60
  s_add_u32 m0, s56, 24576
  s_nop 0
  buffer_load_dwordx4 v2, s[36:39], s59 offen lds
  s_add_u32 s59, s59, s60
  s_add_u32 m0, s56, 28672
  s_nop 0
  buffer_load_dwordx4 v2, s[36:39], s59 offen lds
  s_add_u32 s59, s59, s60
  s_waitcnt vmcnt(4)
  s_barrier
  s_add_u32 m0, s56, 32768
  s_nop 0
  buffer_load_dwordx4 v2, s[36:39], s59 offen lds
  s_add_u32 s59, s59, s60
  s_add_u32 m0, s56, 36864
  s_nop 0
  buffer_load_dwordx4 v2, s[36:39], s59 offen lds
  s_add_u32 s59, s59, s60
  s_add_u32 m0, s56, 40960
  s_nop 0
  buffer_load_dwordx4 v2, s[36:39], s59 offen lds
  s_add_u32 s59, s59, s60
  s_add_u32 m0, s56, 45056
  s_nop 0
  buffer_load_dwordx4 v2, s[36:39], s59 offen lds
  s_add_u32 s59, s59, s60
  s_waitcnt vmcnt(4)
  s_barrier
  s_add_u32 m0, s56, 0
  s_nop 0
  buffer_load_dwordx4 v2, s[36:39], s59 offen lds
  s_add_u32 s59, s59, s60
  s_add_u32 m0, s56, 4096
  s_nop 0
  buffer_load_dwordx4 v2, s[36:39], s59 offen lds
  s_add_u32 s59, s59, s60
  s_add_u32 m0, s56, 8192
  s_nop 0
  buffer_load_dwordx4 v2, s[36:39], s59 offen lds
  s_add_u32 s59, s59, s60
  s_add_u32 m0, s56, 12288
  s_nop 0
  buffer_load_dwordx4 v2, s[36:39], s59 offen lds
  s_add_u32 s59, s59, s60
  s_waitcnt vmcnt(4)
  s_barrier
  s_add_u32 m0, s56, 16384
  s_nop 0
  buffer_load_dwordx4 v2, s[36:39], s59 offen lds
  s_add_u32 s59, s59, s60
  s_add_u32 m0, s56, 20480
  s_nop 0
  buffer_load_dwordx4 v2, s[36:39], s59 offen lds
  s_add_u32 s59, s59, s60
  s_add_u32 m0, s56, 24576
  s_nop 0
  buffer_load_dwordx4 v2, s[36:39], s59 offen lds
  s_add_u32 s59, s59, s60
  s_add_u32 m0, s56, 28672
  s_nop 0
  buffer_load_dwordx4 v2, s[36:39], s59 offen lds
  s_add_u32 s59, s59, s60
  s_waitcnt vmcnt(4)
  s_barrier
  s_add_u32 m0, s56, 32768
  s_nop 0
  buffer_load_dwordx4 v2, s[36:39], s59 offen lds
  s_add_u32 s59, s59, s60
  s_add_u32 m0, s56, 36864
  s_nop 0
  buffer_load_dwordx4 v2, s[36:39], s59 offen lds
  s_add_u32 s59, s59, s60
  s_add_u32 m0, s56, 40960
  s_nop 0
  buffer_load_dwordx4 v2, s[36:39], s59 offen lds
  s_add_u32 s59, s59, s60
  s_add_u32 m0, s56, 45056
  s_nop 0
  buffer_load_dwordx4 v2, s[36:39], s59 offen lds
  s_add_u32 s59, s59, s60
  s_waitcnt vmcnt(4)
  s_barrier
  s_add_u32 m0, s56, 0
  s_nop 0
  buffer_load_dwordx4 v2, s[36:39], s59 offen lds
  s_add_u32 s59, s59, s60
  s_add_u32 m0, s56, 4096
  s_nop 0
  buffer_load_dwordx4 v2, s[36:39], s59 offen lds
  s_add_u32 s59, s59, s60
  s_add_u32 m0, s56, 8192
  s_nop 0
  buffer_load_dwordx4 v2, s[36:39], s59 offen lds
  s_add_u32 s59, s59, s60
  s_add_u32 m0, s56, 12288
  s_nop 0
  buffer_load_dwordx4 v2, s[36:39], s59 offen lds
  s_add_u32 s59, s59, s60
  s_waitcnt vmcnt(4)
  s_barrier
  s_add_u32 m0, s56, 16384
  s_nop 0
  buffer_load_dwordx4 v2, s[36:39], s59 offen lds
  s_add_u32 s59, s59, s60
  s_add_u32 m0, s56, 20480
  s_nop 0
  buffer_load_dwordx4 v2, s[36:39], s59 offen lds
  s_add_u32 s59, s59, s60
  s_add_u32 m0, s56, 24576
  s_nop 0
  buffer_load_dwordx4 v2, s[36:39], s59 offen lds
  s_add_u32 s59, s59, s60
  s_add_u32 m0, s56, 28672
  s_nop 0
  buffer_load_dwordx4 v2, s[36:39], s59 offen lds
  s_add_u32 s59, s59, s60
  s_waitcnt vmcnt(4)
  s_lshr_b32 s31, s2, 3
  s_lshl_b32 s31, s31, 8
  s_add_u32 s31, s31, 2719744
  v_min_u32 v9, 38, v1
  v_lshl_add_u32 v9, v9, 2, s31
  v_mov_b32 v10, 0
  v_mov_b32 v35, 65536
  v_mov_b32 v36, 0
  s_mov_b32 s33, 0
  s_cmp_lg_u32 s34, 1
  s_cbranch_scc1 L_p1h_nkv11
  s_cmp_lg_u32 s33, 0
  s_cbranch_scc1 L_p1h_nkv11
  global_load_dword v10, v9, s[26:27] sc1
L_p1h_nkv11:
  s_barrier
  s_waitcnt vmcnt(0)
  s_cmp_lg_u32 s34, 1
  s_cbranch_scc1 L_p1h_nrl12
  s_waitcnt vmcnt(0)
  v_cmp_ne_u32 vcc, s35, v10
  s_nop 1
  s_cmp_eq_u64 vcc, 0
  s_cselect_b32 s33, 1, 0
  v_mov_b32 v34, s33
  ds_write2_b32 v35, v34, v36 offset0:0 offset1:1
  s_waitcnt lgkmcnt(0)
L_p1h_nrl12:
  s_cmp_lg_u32 s34, 1
  s_cbranch_scc1 L_p1h_nkv12
  s_cmp_lg_u32 s33, 0
  s_cbranch_scc1 L_p1h_nkv12
  global_load_dword v10, v9, s[26:27] sc1
L_p1h_nkv12:
  s_barrier
  s_cmp_lg_u32 s34, 1
  s_cbranch_scc1 L_p1h_nrl13
  s_waitcnt vmcnt(0)
  v_cmp_ne_u32 vcc, s35, v10
  s_nop 1
  s_cmp_eq_u64 vcc, 0
  s_cselect_b32 s33, 1, 0
  v_mov_b32 v34, s33
  ds_write2_b32 v35, v34, v36 offset0:0 offset1:1
  s_waitcnt lgkmcnt(0)
L_p1h_nrl13:
  s_barrier
  s_sub_u32 s53, s30, 4
  s_cmp_lg_u32 s53, 1
  s_cbranch_scc1 L_b_nokv
  s_cmp_lg_u32 s33, 0
  s_cbranch_scc1 L_b_nokv
  s_mov_b32 s48, 200000
  global_load_dword v10, v9, s[26:27] sc1
L_pollkv:
  s_waitcnt vmcnt(0)
  v_cmp_ne_u32 vcc, s35, v10
  s_sub_u32 s48, s48, 1
  s_cmp_eq_u32 s48, 0
  s_cbranch_scc1 L_polldkv
  s_cbranch_vccz L_polldkv
  s_sleep 4
  global_load_dword v10, v9, s[26:27] sc1
  s_branch L_pollkv
L_polldkv:
  v_mov_b32 v2, 65536
  v_mov_b32 v3, s35
  ds_write_b32 v2, v3
  s_waitcnt lgkmcnt(0)
L_b_nokv:
  s_and_b32 s49, s2, 7
  s_lshr_b32 s50, s2, 3
  s_lshl_b32 s51, s49, 5
  s_add_u32 s51, s51, s50
  s_cmp_lt_u32 s49, 4
  s_cbranch_scc1 L_b_tile
  s_cmp_lt_u32 s50, 8
  s_cbranch_scc1 L_end
  s_mul_i32 s51, s49, 24
  s_add_u32 s51, s51, s50
  s_add_u32 s51, s51, 24
L_b_tile:
  s_mul_i32 s49, s51, 9363
  s_lshr_b32 s49, s49, 16
  s_mul_i32 s50, s49, 7
  s_sub_u32 s52, s51, s50
  s_mov_b32 s51, s49
  v_and_b32 v1, 63, v0
  v_lshrrev_b32 v2, 3, v1
  v_mul_u32_u24 v8, 896, v2
  v_bfe_u32 v3, v1, 4, 1
  v_lshlrev_b32 v3, 2, v3
  v_and_b32 v4, 7, v1
  v_xor_b32 v3, v3, v4
  v_lshl_add_u32 v8, v3, 4, v8
  v_lshrrev_b32 v2, 5, v1
  v_lshlrev_b32 v2, 10, v2
  v_bfe_u32 v3, v1, 2, 2
  v_lshl_add_u32 v2, v3, 7, v2
  v_and_b32 v3, 1, v1
  v_lshl_add_u32 v2, v3, 5, v2
  v_bfe_u32 v3, v1, 4, 1
  v_lshl_add_u32 v2, v3, 4, v2
  v_bfe_u32 v3, v1, 1, 1
  v_lshl_add_u32 v2, v3, 3, v2
  v_bfe_u32 v3, v1, 3, 1
  s_and_b32 s49, s53, 1
  v_xor_b32 v3, s49, v3
  v_lshl_add_u32 v10, v3, 6, v2
  v_xor_b32 v11, 64, v10
  s_add_u32 s36, s20, 0
  s_addc_u32 s37, s21, 0
  s_and_b32 s37, s37, 0xffff
  s_mov_b32 s38, 1605632
  s_mov_b32 s39, 0x00020000
  s_add_u32 s40, s26, 4194304
  s_addc_u32 s41, s27, 0
  s_and_b32 s41, s41, 0xffff
  s_mov_b32 s42, 7340032
  s_mov_b32 s43, 0x00020000
  s_lshl_b32 s47, s53, 14
  v_add_u32 v10, s47, v10
  v_add_u32 v11, s47, v11
  s_mul_i32 s44, s53, 401408
  s_lshl_b32 s49, s52, 7
  s_add_u32 s44, s44, s49
  s_add_u32 m0, s47, 0
  s_nop 0
  buffer_load_dwordx4 v8, s[36:39], s44 offen lds
  s_add_u32 m0, s47, 1024
  s_add_u32 s45, s44, 7168
  buffer_load_dwordx4 v8, s[36:39], s45 offen lds
  s_add_u32 s44, s44, 14336
  s_add_u32 m0, s47, 2048
  s_nop 0
  buffer_load_dwordx4 v8, s[36:39], s44 offen lds
  s_add_u32 m0, s47, 3072
  s_add_u32 s45, s44, 7168
  buffer_load_dwordx4 v8, s[36:39], s45 offen lds
  s_add_u32 s44, s44, 14336
  s_add_u32 m0, s47, 4096
  s_nop 0
  buffer_load_dwordx4 v8, s[36:39], s44 offen lds
  s_add_u32 m0, s47, 5120
  s_add_u32 s45, s44, 7168
  buffer_load_dwordx4 v8, s[36:39], s45 offen lds
  s_add_u32 s44, s44, 14336
  s_add_u32 m0, s47, 6144
  s_nop 0
  buffer_load_dwordx4 v8, s[36:39], s44 offen lds
  s_add_u32 m0, s47, 7168
  s_add_u32 s45, s44, 7168
  buffer_load_dwordx4 v8, s[36:39], s45 offen lds
  s_add_u32 s44, s44, 14336
  s_add_u32 m0, s47, 8192
  s_nop 0
  buffer_load_dwordx4 v8, s[36:39], s44 offen lds
  s_add_u32 m0, s47, 9216
  s_add_u32 s45, s44, 7168
  buffer_load_dwordx4 v8, s[36:39], s45 offen lds
  s_add_u32 s44, s44, 14336
  s_add_u32 m0, s47, 10240
  s_nop 0
  buffer_load_dwordx4 v8, s[36:39], s44 offen lds
  s_add_u32 m0, s47, 11264
  s_add_u32 s45, s44, 7168
  buffer_load_dwordx4 v8, s[36:39], s45 offen lds
  s_add_u32 s44, s44, 14336
  s_add_u32 m0, s47, 12288
  s_nop 0
  buffer_load_dwordx4 v8, s[36:39], s44 offen lds
  s_add_u32 m0, s47, 13312
  s_add_u32 s45, s44, 7168
  buffer_load_dwordx4 v8, s[36:39], s45 offen lds
  s_add_u32 s44, s44, 14336
  s_add_u32 m0, s47, 14336
  s_nop 0
  buffer_load_dwordx4 v8, s[36:39], s44 offen lds
  s_add_u32 m0, s47, 15360
  s_add_u32 s45, s44, 7168
  buffer_load_dwordx4 v8, s[36:39], s45 offen lds
  s_add_u32 s44, s44, 14336
  s_lshr_b32 s54, s53, 1
  s_lshl_b32 s50, s51, 1
  s_add_u32 s54, s54, s50
  s_xor_b32 s50, s54, 1
  s_mul_i32 s49, s54, 114688
  s_mul_i32 s50, s50, 114688
  v_lshlrev_b32 v2, 4, v1
  v_add_u32 v12, s49, v2
  v_add_u32 v13, s50, v2
  s_mul_i32 s46, s53, 28672
  v_and_b32 v9, 31, v1
  s_lshl_b32 s49, s51, 7
  s_add_u32 s49, s49, 2689024
  v_lshl_add_u32 v14, v9, 2, s49
  s_cmp_lg_u32 s53, 0
  s_cbranch_scc1 L_b_hw
  s_sleep 24
  s_mov_b32 s48, 200000
  global_load_dword v15, v14, s[26:27] sc1
L_pollh:
  s_waitcnt vmcnt(0)
  v_cmp_ne_u32 vcc, s35, v15
  s_sub_u32 s48, s48, 1
  s_cmp_eq_u32 s48, 0
  s_cbranch_scc1 L_polldh
  s_cbranch_vccz L_polldh
  s_sleep 12
  global_load_dword v15, v14, s[26:27] sc1
  s_branch L_pollh
L_polldh:
  v_mov_b32 v4, 65540
  v_mov_b32 v5, s35
  ds_write_b32 v4, v5
L_b_hw:
  v_mov_b32 v4, 65540
  s_mov_b32 s48, 3200000
L_rwh:
  ds_read_b32 v5, v4
  s_waitcnt lgkmcnt(0)
  v_readfirstlane_b32 s49, v5
  s_sub_u32 s48, s48, 1
  s_cmp_eq_u32 s48, 0
  s_cbranch_scc1 L_rwdh
  s_cmp_lg_u32 s49, 0
  s_cbranch_scc1 L_rwdh
  s_sleep 1
  s_branch L_rwh
L_rwdh:
  s_waitcnt vmcnt(0)
  s_lshl_b32 s50, s54, 8
  s_add_u32 s50, s50, 2621440
  v_lshl_add_u32 v9, v9, 3, s50
  global_load_dword v9, v9, s[26:27] sc1
  buffer_load_dwordx4 v[96:99], v12, s[40:43], s46 offen offset:0
  buffer_load_dwordx4 v[100:103], v13, s[40:43], s46 offen offset:0
  buffer_load_dwordx4 v[104:107], v12, s[40:43], s46 offen offset:1024
  buffer_load_dwordx4 v[108:111], v13, s[40:43], s46 offen offset:1024
  buffer_load_dwordx4 v[112:115], v12, s[40:43], s46 offen offset:2048
  buffer_load_dwordx4 v[116:119], v13, s[40:43], s46 offen offset:2048
  buffer_load_dwordx4 v[120:123], v12, s[40:43], s46 offen offset:3072
  buffer_load_dwordx4 v[124:127], v13, s[40:43], s46 offen offset:3072
  s_add_u32 s46, s46, 4096
  buffer_load_dwordx4 v[128:131], v12, s[40:43], s46 offen offset:0
  buffer_load_dwordx4 v[132:135], v13, s[40:43], s46 offen offset:0
  buffer_load_dwordx4 v[136:139], v12, s[40:43], s46 offen offset:1024
  buffer_load_dwordx4 v[140:143], v13, s[40:43], s46 offen offset:1024
  buffer_load_dwordx4 v[144:147], v12, s[40:43], s46 offen offset:2048
  buffer_load_dwordx4 v[148:151], v13, s[40:43], s46 offen offset:2048
  buffer_load_dwordx4 v[152:155], v12, s[40:43], s46 offen offset:3072
  buffer_load_dwordx4 v[156:159], v13, s[40:43], s46 offen offset:3072
  s_add_u32 s46, s46, 4096
  ds_read_b64_tr_b16 v[80:81], v10 offset:0
  ds_read_b64_tr_b16 v[82:83], v10 offset:512
  ds_read_b64_tr_b16 v[84:85], v11 offset:0
  ds_read_b64_tr_b16 v[86:87], v11 offset:512
  s_waitcnt vmcnt(14)
  s_waitcnt lgkmcnt(0)
  ds_read_b64_tr_b16 v[88:89], v10 offset:2048
  ds_read_b64_tr_b16 v[90:91], v10 offset:2560
  ds_read_b64_tr_b16 v[92:93], v11 offset:2048
  ds_read_b64_tr_b16 v[94:95], v11 offset:2560
  v_mfma_f32_32x32x16_bf16 v[16:31], v[80:83], v[96:99], 0
  v_mfma_f32_32x32x16_bf16 v[32:47], v[84:87], v[96:99], 0
  v_mfma_f32_32x32x16_bf16 v[48:63], v[80:83], v[100:103], 0
  v_mfma_f32_32x32x16_bf16 v[64:79], v[84:87], v[100:103], 0
  s_add_u32 m0, s47, 0
  s_nop 0
  buffer_load_dwordx4 v8, s[36:39], s44 offen lds
  s_add_u32 m0, s47, 1024
  s_add_u32 s45, s44, 7168
  buffer_load_dwordx4 v8, s[36:39], s45 offen lds
  s_add_u32 s44, s44, 14336
  buffer_load_dwordx4 v[96:99], v12, s[40:43], s46 offen offset:0
  buffer_load_dwordx4 v[100:103], v13, s[40:43], s46 offen offset:0
  s_waitcnt vmcnt(16)
  s_waitcnt lgkmcnt(0)
  ds_read_b64_tr_b16 v[80:81], v10 offset:4096
  ds_read_b64_tr_b16 v[82:83], v10 offset:4608
  ds_read_b64_tr_b16 v[84:85], v11 offset:4096
  ds_read_b64_tr_b16 v[86:87], v11 offset:4608
  v_mfma_f32_32x32x16_bf16 v[16:31], v[88:91], v[104:107], v[16:31]
  v_mfma_f32_32x32x16_bf16 v[32:47], v[92:95], v[104:107], v[32:47]
  v_mfma_f32_32x32x16_bf16 v[48:63], v[88:91], v[108:111], v[48:63]
  v_mfma_f32_32x32x16_bf16 v[64:79], v[92:95], v[108:111], v[64:79]
  s_add_u32 m0, s47, 2048
  s_nop 0
  buffer_load_dwordx4 v8, s[36:39], s44 offen lds
  s_add_u32 m0, s47, 3072
  s_add_u32 s45, s44, 7168
  buffer_load_dwordx4 v8, s[36:39], s45 offen lds
  s_add_u32 s44, s44, 14336
  buffer_load_dwordx4 v[104:107], v12, s[40:43], s46 offen offset:1024
  buffer_load_dwordx4 v[108:111], v13, s[40:43], s46 offen offset:1024
  s_waitcnt vmcnt(18)
  s_waitcnt lgkmcnt(0)
  ds_read_b64_tr_b16 v[88:89], v10 offset:6144
  ds_read_b64_tr_b16 v[90:91], v10 offset:6656
  ds_read_b64_tr_b16 v[92:93], v11 offset:6144
  ds_read_b64_tr_b16 v[94:95], v11 offset:6656
  v_mfma_f32_32x32x16_bf16 v[16:31], v[80:83], v[112:115], v[16:31]
  v_mfma_f32_32x32x16_bf16 v[32:47], v[84:87], v[112:115], v[32:47]
  v_mfma_f32_32x32x16_bf16 v[48:63], v[80:83], v[116:119], v[48:63]
  v_mfma_f32_32x32x16_bf16 v[64:79], v[84:87], v[116:119], v[64:79]
  s_add_u32 m0, s47, 4096
  s_nop 0
  buffer_load_dwordx4 v8, s[36:39], s44 offen lds
  s_add_u32 m0, s47, 5120
  s_add_u32 s45, s44, 7168
  buffer_load_dwordx4 v8, s[36:39], s45 offen lds
  s_add_u32 s44, s44, 14336
  buffer_load_dwordx4 v[112:115], v12, s[40:43], s46 offen offset:2048
  buffer_load_dwordx4 v[116:119], v13, s[40:43], s46 offen offset:2048
  s_waitcnt vmcnt(20)
  s_waitcnt lgkmcnt(0)
  ds_read_b64_tr_b16 v[80:81], v10 offset:8192
  ds_read_b64_tr_b16 v[82:83], v10 offset:8704
  ds_read_b64_tr_b16 v[84:85], v11 offset:8192
  ds_read_b64_tr_b16 v[86:87], v11 offset:8704
  v_mfma_f32_32x32x16_bf16 v[16:31], v[88:91], v[120:123], v[16:31]
  v_mfma_f32_32x32x16_bf16 v[32:47], v[92:95], v[120:123], v[32:47]
  v_mfma_f32_32x32x16_bf16 v[48:63], v[88:91], v[124:127], v[48:63]
  v_mfma_f32_32x32x16_bf16 v[64:79], v[92:95], v[124:127], v[64:79]
  s_add_u32 m0, s47, 6144
  s_nop 0
  buffer_load_dwordx4 v8, s[36:39], s44 offen lds
  s_add_u32 m0, s47, 7168
  s_add_u32 s45, s44, 7168
  buffer_load_dwordx4 v8, s[36:39], s45 offen lds
  s_add_u32 s44, s44, 14336
  buffer_load_dwordx4 v[120:123], v12, s[40:43], s46 offen offset:3072
  buffer_load_dwordx4 v[124:127], v13, s[40:43], s46 offen offset:3072
  s_add_u32 s46, s46, 4096
  s_waitcnt vmcnt(22)
  s_waitcnt lgkmcnt(0)
  ds_read_b64_tr_b16 v[88:89], v10 offset:10240
  ds_read_b64_tr_b16 v[90:91], v10 offset:10752
  ds_read_b64_tr_b16 v[92:93], v11 offset:10240
  ds_read_b64_tr_b16 v[94:95], v11 offset:10752
  v_mfma_f32_32x32x16_bf16 v[16:31], v[80:83], v[128:131], v[16:31]
  v_mfma_f32_32x32x16_bf16 v[32:47], v[84:87], v[128:131], v[32:47]
  v_mfma_f32_32x32x16_bf16 v[48:63], v[80:83], v[132:135], v[48:63]
  v_mfma_f32_32x32x16_bf16 v[64:79], v[84:87], v[132:135], v[64:79]
  s_add_u32 m0, s47, 8192
  s_nop 0
  buffer_load_dwordx4 v8, s[36:39], s44 offen lds
  s_add_u32 m0, s47, 9216
  s_add_u32 s45, s44, 7168
  buffer_load_dwordx4 v8, s[36:39], s45 offen lds
  s_add_u32 s44, s44, 14336
  buffer_load_dwordx4 v[128:131], v12, s[40:43], s46 offen offset:0
  buffer_load_dwordx4 v[132:135], v13, s[40:43], s46 offen offset:0
  s_waitcnt vmcnt(24)
  s_waitcnt lgkmcnt(0)
  ds_read_b64_tr_b16 v[80:81], v10 offset:12288
  ds_read_b64_tr_b16 v[82:83], v10 offset:12800
  ds_read_b64_tr_b16 v[84:85], v11 offset:12288
  ds_read_b64_tr_b16 v[86:87], v11 offset:12800
  v_mfma_f32_32x32x16_bf16 v[16:31], v[88:91], v[136:139], v[16:31]
  v_mfma_f32_32x32x16_bf16 v[32:47], v[92:95], v[136:139], v[32:47]
  v_mfma_f32_32x32x16_bf16 v[48:63], v[88:91], v[140:143], v[48:63]
  v_mfma_f32_32x32x16_bf16 v[64:79], v[92:95], v[140:143], v[64:79]
  s_add_u32 m0, s47, 10240
  s_nop 0
  buffer_load_dwordx4 v8, s[36:39], s44 offen lds
  s_add_u32 m0, s47, 11264
  s_add_u32 s45, s44, 7168
  buffer_load_dwordx4 v8, s[36:39], s45 offen lds
  s_add_u32 s44, s44, 14336
  buffer_load_dwordx4 v[136:139], v12, s[40:43], s46 offen offset:1024
  buffer_load_dwordx4 v[140:143], v13, s[40:43], s46 offen offset:1024
  s_waitcnt vmcnt(26)
  s_waitcnt lgkmcnt(0)
  ds_read_b64_tr_b16 v[88:89], v10 offset:14336
  ds_read_b64_tr_b16 v[90:91], v10 offset:14848
  ds_read_b64_tr_b16 v[92:93], v11 offset:14336
  ds_read_b64_tr_b16 v[94:95], v11 offset:14848
  v_mfma_f32_32x32x16_bf16 v[16:31], v[80:83], v[144:147], v[16:31]
  v_mfma_f32_32x32x16_bf16 v[32:47], v[84:87], v[144:147], v[32:47]
  v_mfma_f32_32x32x16_bf16 v[48:63], v[80:83], v[148:151], v[48:63]
  v_mfma_f32_32x32x16_bf16 v[64:79], v[84:87], v[148:151], v[64:79]
  s_add_u32 m0, s47, 12288
  s_nop 0
  buffer_load_dwordx4 v8, s[36:39], s44 offen lds
  s_add_u32 m0, s47, 13312
  s_add_u32 s45, s44, 7168
  buffer_load_dwordx4 v8, s[36:39], s45 offen lds
  s_add_u32 s44, s44, 14336
  buffer_load_dwordx4 v[144:147], v12, s[40:43], s46 offen offset:2048
  buffer_load_dwordx4 v[148:151], v13, s[40:43], s46 offen offset:2048
  s_waitcnt vmcnt(26)
  s_waitcnt lgkmcnt(0)
  ds_read_b64_tr_b16 v[80:81], v10 offset:0
  ds_read_b64_tr_b16 v[82:83], v10 offset:512
  ds_read_b64_tr_b16 v[84:85], v11 offset:0
  ds_read_b64_tr_b16 v[86:87], v11 offset:512
  v_mfma_f32_32x32x16_bf16 v[16:31], v[88:91], v[152:155], v[16:31]
  v_mfma_f32_32x32x16_bf16 v[32:47], v[92:95], v[152:155], v[32:47]
  v_mfma_f32_32x32x16_bf16 v[48:63], v[88:91], v[156:159], v[48:63]
  v_mfma_f32_32x32x16_bf16 v[64:79], v[92:95], v[156:159], v[64:79]
  s_add_u32 m0, s47, 14336
  s_nop 0
  buffer_load_dwordx4 v8, s[36:39], s44 offen lds
  s_add_u32 m0, s47, 15360
  s_add_u32 s45, s44, 7168
  buffer_load_dwordx4 v8, s[36:39], s45 offen lds
  s_add_u32 s44, s44, 14336
  buffer_load_dwordx4 v[152:155], v12, s[40:43], s46 offen offset:3072
  buffer_load_dwordx4 v[156:159], v13, s[40:43], s46 offen offset:3072
  s_add_u32 s46, s46, 4096
  s_waitcnt vmcnt(26)
  s_waitcnt lgkmcnt(0)
  ds_read_b64_tr_b16 v[88:89], v10 offset:2048
  ds_read_b64_tr_b16 v[90:91], v10 offset:2560
  ds_read_b64_tr_b16 v[92:93], v11 offset:2048
  ds_read_b64_tr_b16 v[94:95], v11 offset:2560
  v_mfma_f32_32x32x16_bf16 v[16:31], v[80:83], v[96:99], v[16:31]
  v_mfma_f32_32x32x16_bf16 v[32:47], v[84:87], v[96:99], v[32:47]
  v_mfma_f32_32x32x16_bf16 v[48:63], v[80:83], v[100:103], v[48:63]
  v_mfma_f32_32x32x16_bf16 v[64:79], v[84:87], v[100:103], v[64:79]
  s_add_u32 m0, s47, 0
  s_nop 0
  buffer_load_dwordx4 v8, s[36:39], s44 offen lds
  s_add_u32 m0, s47, 1024
  s_add_u32 s45, s44, 7168
  buffer_load_dwordx4 v8, s[36:39], s45 offen lds
  s_add_u32 s44, s44, 14336
  buffer_load_dwordx4 v[96:99], v12, s[40:43], s46 offen offset:0
  buffer_load_dwordx4 v[100:103], v13, s[40:43], s46 offen offset:0
  s_waitcnt vmcnt(26)
  s_waitcnt lgkmcnt(0)
  ds_read_b64_tr_b16 v[80:81], v10 offset:4096
  ds_read_b64_tr_b16 v[82:83], v10 offset:4608
  ds_read_b64_tr_b16 v[84:85], v11 offset:4096
  ds_read_b64_tr_b16 v[86:87], v11 offset:4608
  v_mfma_f32_32x32x16_bf16 v[16:31], v[88:91], v[104:107], v[16:31]
  v_mfma_f32_32x32x16_bf16 v[32:47], v[92:95], v[104:107], v[32:47]
  v_mfma_f32_32x32x16_bf16 v[48:63], v[88:91], v[108:111], v[48:63]
  v_mfma_f32_32x32x16_bf16 v[64:79], v[92:95], v[108:111], v[64:79]
  s_add_u32 m0, s47, 2048
  s_nop 0
  buffer_load_dwordx4 v8, s[36:39], s44 offen lds
  s_add_u32 m0, s47, 3072
  s_add_u32 s45, s44, 7168
  buffer_load_dwordx4 v8, s[36:39], s45 offen lds
  s_add_u32 s44, s44, 14336
  buffer_load_dwordx4 v[104:107], v12, s[40:43], s46 offen offset:1024
  buffer_load_dwordx4 v[108:111], v13, s[40:43], s46 offen offset:1024
  s_waitcnt vmcnt(26)
  s_waitcnt lgkmcnt(0)
  ds_read_b64_tr_b16 v[88:89], v10 offset:6144
  ds_read_b64_tr_b16 v[90:91], v10 offset:6656
  ds_read_b64_tr_b16 v[92:93], v11 offset:6144
  ds_read_b64_tr_b16 v[94:95], v11 offset:6656
  v_mfma_f32_32x32x16_bf16 v[16:31], v[80:83], v[112:115], v[16:31]
  v_mfma_f32_32x32x16_bf16 v[32:47], v[84:87], v[112:115], v[32:47]
  v_mfma_f32_32x32x16_bf16 v[48:63], v[80:83], v[116:119], v[48:63]
  v_mfma_f32_32x32x16_bf16 v[64:79], v[84:87], v[116:119], v[64:79]
  s_add_u32 m0, s47, 4096
  s_nop 0
  buffer_load_dwordx4 v8, s[36:39], s44 offen lds
  s_add_u32 m0, s47, 5120
  s_add_u32 s45, s44, 7168
  buffer_load_dwordx4 v8, s[36:39], s45 offen lds
  s_add_u32 s44, s44, 14336
  buffer_load_dwordx4 v[112:115], v12, s[40:43], s46 offen offset:2048
  buffer_load_dwordx4 v[116:119], v13, s[40:43], s46 offen offset:2048
  s_waitcnt vmcnt(26)
  s_waitcnt lgkmcnt(0)
  ds_read_b64_tr_b16 v[80:81], v10 offset:8192
  ds_read_b64_tr_b16 v[82:83], v10 offset:8704
  ds_read_b64_tr_b16 v[84:85], v11 offset:8192
  ds_read_b64_tr_b16 v[86:87], v11 offset:8704
  v_mfma_f32_32x32x16_bf16 v[16:31], v[88:91], v[120:123], v[16:31]
  v_mfma_f32_32x32x16_bf16 v[32:47], v[92:95], v[120:123], v[32:47]
  v_mfma_f32_32x32x16_bf16 v[48:63], v[88:91], v[124:127], v[48:63]
  v_mfma_f32_32x32x16_bf16 v[64:79], v[92:95], v[124:127], v[64:79]
  s_add_u32 m0, s47, 6144
  s_nop 0
  buffer_load_dwordx4 v8, s[36:39], s44 offen lds
  s_add_u32 m0, s47, 7168
  s_add_u32 s45, s44, 7168
  buffer_load_dwordx4 v8, s[36:39], s45 offen lds
  s_add_u32 s44, s44, 14336
  buffer_load_dwordx4 v[120:123], v12, s[40:43], s46 offen offset:3072
  buffer_load_dwordx4 v[124:127], v13, s[40:43], s46 offen offset:3072
  s_add_u32 s46, s46, 4096
  s_waitcnt vmcnt(26)
  s_waitcnt lgkmcnt(0)
  ds_read_b64_tr_b16 v[88:89], v10 offset:10240
  ds_read_b64_tr_b16 v[90:91], v10 offset:10752
  ds_read_b64_tr_b16 v[92:93], v11 offset:10240
  ds_read_b64_tr_b16 v[94:95], v11 offset:10752
  v_mfma_f32_32x32x16_bf16 v[16:31], v[80:83], v[128:131], v[16:31]
  v_mfma_f32_32x32x16_bf16 v[32:47], v[84:87], v[128:131], v[32:47]
  v_mfma_f32_32x32x16_bf16 v[48:63], v[80:83], v[132:135], v[48:63]
  v_mfma_f32_32x32x16_bf16 v[64:79], v[84:87], v[132:135], v[64:79]
  s_add_u32 m0, s47, 8192
  s_nop 0
  buffer_load_dwordx4 v8, s[36:39], s44 offen lds
  s_add_u32 m0, s47, 9216
  s_add_u32 s45, s44, 7168
  buffer_load_dwordx4 v8, s[36:39], s45 offen lds
  s_add_u32 s44, s44, 14336
  buffer_load_dwordx4 v[128:131], v12, s[40:43], s46 offen offset:0
  buffer_load_dwordx4 v[132:135], v13, s[40:43], s46 offen offset:0
  s_waitcnt vmcnt(26)
  s_waitcnt lgkmcnt(0)
  ds_read_b64_tr_b16 v[80:81], v10 offset:12288
  ds_read_b64_tr_b16 v[82:83], v10 offset:12800
  ds_read_b64_tr_b16 v[84:85], v11 offset:12288
  ds_read_b64_tr_b16 v[86:87], v11 offset:12800
  v_mfma_f32_32x32x16_bf16 v[16:31], v[88:91], v[136:139], v[16:31]
  v_mfma_f32_32x32x16_bf16 v[32:47], v[92:95], v[136:139], v[32:47]
  v_mfma_f32_32x32x16_bf16 v[48:63], v[88:91], v[140:143], v[48:63]
  v_mfma_f32_32x32x16_bf16 v[64:79], v[92:95], v[140:143], v[64:79]
  s_add_u32 m0, s47, 10240
  s_nop 0
  buffer_load_dwordx4 v8, s[36:39], s44 offen lds
  s_add_u32 m0, s47, 11264
  s_add_u32 s45, s44, 7168
  buffer_load_dwordx4 v8, s[36:39], s45 offen lds
  s_add_u32 s44, s44, 14336
  buffer_load_dwordx4 v[136:139], v12, s[40:43], s46 offen offset:1024
  buffer_load_dwordx4 v[140:143], v13, s[40:43], s46 offen offset:1024
  s_waitcnt vmcnt(26)
  s_waitcnt lgkmcnt(0)
  ds_read_b64_tr_b16 v[88:89], v10 offset:14336
  ds_read_b64_tr_b16 v[90:91], v10 offset:14848
  ds_read_b64_tr_b16 v[92:93], v11 offset:14336
  ds_read_b64_tr_b16 v[94:95], v11 offset:14848
  v_mfma_f32_32x32x16_bf16 v[16:31], v[80:83], v[144:147], v[16:31]
  v_mfma_f32_32x32x16_bf16 v[32:47], v[84:87], v[144:147], v[32:47]
  v_mfma_f32_32x32x16_bf16 v[48:63], v[80:83], v[148:151], v[48:63]
  v_mfma_f32_32x32x16_bf16 v[64:79], v[84:87], v[148:151], v[64:79]
  s_add_u32 m0, s47, 12288
  s_nop 0
  buffer_load_dwordx4 v8, s[36:39], s44 offen lds
  s_add_u32 m0, s47, 13312
  s_add_u32 s45, s44, 7168
  buffer_load_dwordx4 v8, s[36:39], s45 offen lds
  s_add_u32 s44, s44, 14336
  buffer_load_dwordx4 v[144:147], v12, s[40:43], s46 offen offset:2048
  buffer_load_dwordx4 v[148:151], v13, s[40:43], s46 offen offset:2048
  s_waitcnt vmcnt(26)
  s_waitcnt lgkmcnt(0)
  ds_read_b64_tr_b16 v[80:81], v10 offset:0
  ds_read_b64_tr_b16 v[82:83], v10 offset:512
  ds_read_b64_tr_b16 v[84:85], v11 offset:0
  ds_read_b64_tr_b16 v[86:87], v11 offset:512
  v_mfma_f32_32x32x16_bf16 v[16:31], v[88:91], v[152:155], v[16:31]
  v_mfma_f32_32x32x16_bf16 v[32:47], v[92:95], v[152:155], v[32:47]
  v_mfma_f32_32x32x16_bf16 v[48:63], v[88:91], v[156:159], v[48:63]
  v_mfma_f32_32x32x16_bf16 v[64:79], v[92:95], v[156:159], v[64:79]
  s_add_u32 m0, s47, 14336
  s_nop 0
  buffer_load_dwordx4 v8, s[36:39], s44 offen lds
  s_add_u32 m0, s47, 15360
  s_add_u32 s45, s44, 7168
  buffer_load_dwordx4 v8, s[36:39], s45 offen lds
  s_add_u32 s44, s44, 14336
  buffer_load_dwordx4 v[152:155], v12, s[40:43], s46 offen offset:3072
  buffer_load_dwordx4 v[156:159], v13, s[40:43], s46 offen offset:3072
  s_add_u32 s46, s46, 4096
  s_waitcnt vmcnt(26)
  s_waitcnt lgkmcnt(0)
  ds_read_b64_tr_b16 v[88:89], v10 offset:2048
  ds_read_b64_tr_b16 v[90:91], v10 offset:2560
  ds_read_b64_tr_b16 v[92:93], v11 offset:2048
  ds_read_b64_tr_b16 v[94:95], v11 offset:2560
  v_mfma_f32_32x32x16_bf16 v[16:31], v[80:83], v[96:99], v[16:31]
  v_mfma_f32_32x32x16_bf16 v[32:47], v[84:87], v[96:99], v[32:47]
  v_mfma_f32_32x32x16_bf16 v[48:63], v[80:83], v[100:103], v[48:63]
  v_mfma_f32_32x32x16_bf16 v[64:79], v[84:87], v[100:103], v[64:79]
  s_add_u32 m0, s47, 0
  s_nop 0
  buffer_load_dwordx4 v8, s[36:39], s44 offen lds
  s_add_u32 m0, s47, 1024
  s_add_u32 s45, s44, 7168
  buffer_load_dwordx4 v8, s[36:39], s45 offen lds
  s_add_u32 s44, s44, 14336
  buffer_load_dwordx4 v[96:99], v12, s[40:43], s46 offen offset:0
  buffer_load_dwordx4 v[100:103], v13, s[40:43], s46 offen offset:0
  s_waitcnt vmcnt(26)
  s_waitcnt lgkmcnt(0)
  ds_read_b64_tr_b16 v[80:81], v10 offset:4096
  ds_read_b64_tr_b16 v[82:83], v10 offset:4608
  ds_read_b64_tr_b16 v[84:85], v11 offset:4096
  ds_read_b64_tr_b16 v[86:87], v11 offset:4608
  v_mfma_f32_32x32x16_bf16 v[16:31], v[88:91], v[104:107], v[16:31]
  v_mfma_f32_32x32x16_bf16 v[32:47], v[92:95], v[104:107], v[32:47]
  v_mfma_f32_32x32x16_bf16 v[48:63], v[88:91], v[108:111], v[48:63]
  v_mfma_f32_32x32x16_bf16 v[64:79], v[92:95], v[108:111], v[64:79]
  s_add_u32 m0, s47, 2048
  s_nop 0
  buffer_load_dwordx4 v8, s[36:39], s44 offen lds
  s_add_u32 m0, s47, 3072
  s_add_u32 s45, s44, 7168
  buffer_load_dwordx4 v8, s[36:39], s45 offen lds
  s_add_u32 s44, s44, 14336
  buffer_load_dwordx4 v[104:107], v12, s[40:43], s46 offen offset:1024
  buffer_load_dwordx4 v[108:111], v13, s[40:43], s46 offen offset:1024
  s_waitcnt vmcnt(26)
  s_waitcnt lgkmcnt(0)
  ds_read_b64_tr_b16 v[88:89], v10 offset:6144
  ds_read_b64_tr_b16 v[90:91], v10 offset:6656
  ds_read_b64_tr_b16 v[92:93], v11 offset:6144
  ds_read_b64_tr_b16 v[94:95], v11 offset:6656
  v_mfma_f32_32x32x16_bf16 v[16:31], v[80:83], v[112:115], v[16:31]
  v_mfma_f32_32x32x16_bf16 v[32:47], v[84:87], v[112:115], v[32:47]
  v_mfma_f32_32x32x16_bf16 v[48:63], v[80:83], v[116:119], v[48:63]
  v_mfma_f32_32x32x16_bf16 v[64:79], v[84:87], v[116:119], v[64:79]
  s_add_u32 m0, s47, 4096
  s_nop 0
  buffer_load_dwordx4 v8, s[36:39], s44 offen lds
  s_add_u32 m0, s47, 5120
  s_add_u32 s45, s44, 7168
  buffer_load_dwordx4 v8, s[36:39], s45 offen lds
  s_add_u32 s44, s44, 14336
  buffer_load_dwordx4 v[112:115], v12, s[40:43], s46 offen offset:2048
  buffer_load_dwordx4 v[116:119], v13, s[40:43], s46 offen offset:2048
  s_waitcnt vmcnt(26)
  s_waitcnt lgkmcnt(0)
  ds_read_b64_tr_b16 v[80:81], v10 offset:8192
  ds_read_b64_tr_b16 v[82:83], v10 offset:8704
  ds_read_b64_tr_b16 v[84:85], v11 offset:8192
  ds_read_b64_tr_b16 v[86:87], v11 offset:8704
  v_mfma_f32_32x32x16_bf16 v[16:31], v[88:91], v[120:123], v[16:31]
  v_mfma_f32_32x32x16_bf16 v[32:47], v[92:95], v[120:123], v[32:47]
  v_mfma_f32_32x32x16_bf16 v[48:63], v[88:91], v[124:127], v[48:63]
  v_mfma_f32_32x32x16_bf16 v[64:79], v[92:95], v[124:127], v[64:79]
  s_add_u32 m0, s47, 6144
  s_nop 0
  buffer_load_dwordx4 v8, s[36:39], s44 offen lds
  s_add_u32 m0, s47, 7168
  s_add_u32 s45, s44, 7168
  buffer_load_dwordx4 v8, s[36:39], s45 offen lds
  s_add_u32 s44, s44, 14336
  buffer_load_dwordx4 v[120:123], v12, s[40:43], s46 offen offset:3072
  buffer_load_dwordx4 v[124:127], v13, s[40:43], s46 offen offset:3072
  s_add_u32 s46, s46, 4096
  s_waitcnt vmcnt(26)
  s_waitcnt lgkmcnt(0)
  ds_read_b64_tr_b16 v[88:89], v10 offset:10240
  ds_read_b64_tr_b16 v[90:91], v10 offset:10752
  ds_read_b64_tr_b16 v[92:93], v11 offset:10240
  ds_read_b64_tr_b16 v[94:95], v11 offset:10752
  v_mfma_f32_32x32x16_bf16 v[16:31], v[80:83], v[128:131], v[16:31]
  v_mfma_f32_32x32x16_bf16 v[32:47], v[84:87], v[128:131], v[32:47]
  v_mfma_f32_32x32x16_bf16 v[48:63], v[80:83], v[132:135], v[48:63]
  v_mfma_f32_32x32x16_bf16 v[64:79], v[84:87], v[132:135], v[64:79]
  s_waitcnt vmcnt(22)
  s_waitcnt lgkmcnt(0)
  ds_read_b64_tr_b16 v[80:81], v10 offset:12288
  ds_read_b64_tr_b16 v[82:83], v10 offset:12800
  ds_read_b64_tr_b16 v[84:85], v11 offset:12288
  ds_read_b64_tr_b16 v[86:87], v11 offset:12800
  v_mfma_f32_32x32x16_bf16 v[16:31], v[88:91], v[136:139], v[16:31]
  v_mfma_f32_32x32x16_bf16 v[32:47], v[92:95], v[136:139], v[32:47]
  v_mfma_f32_32x32x16_bf16 v[48:63], v[88:91], v[140:143], v[48:63]
  v_mfma_f32_32x32x16_bf16 v[64:79], v[92:95], v[140:143], v[64:79]
  s_waitcnt vmcnt(18)
  s_waitcnt lgkmcnt(0)
  ds_read_b64_tr_b16 v[88:89], v10 offset:14336
  ds_read_b64_tr_b16 v[90:91], v10 offset:14848
  ds_read_b64_tr_b16 v[92:93], v11 offset:14336
  ds_read_b64_tr_b16 v[94:95], v11 offset:14848
  v_mfma_f32_32x32x16_bf16 v[16:31], v[80:83], v[144:147], v[16:31]
  v_mfma_f32_32x32x16_bf16 v[32:47], v[84:87], v[144:147], v[32:47]
  v_mfma_f32_32x32x16_bf16 v[48:63], v[80:83], v[148:151], v[48:63]
  v_mfma_f32_32x32x16_bf16 v[64:79], v[84:87], v[148:151], v[64:79]
  s_waitcnt vmcnt(14)
  s_waitcnt lgkmcnt(0)
  ds_read_b64_tr_b16 v[80:81], v10 offset:0
  ds_read_b64_tr_b16 v[82:83], v10 offset:512
  ds_read_b64_tr_b16 v[84:85], v11 offset:0
  ds_read_b64_tr_b16 v[86:87], v11 offset:512
  v_mfma_f32_32x32x16_bf16 v[16:31], v[88:91], v[152:155], v[16:31]
  v_mfma_f32_32x32x16_bf16 v[32:47], v[92:95], v[152:155], v[32:47]
  v_mfma_f32_32x32x16_bf16 v[48:63], v[88:91], v[156:159], v[48:63]
  v_mfma_f32_32x32x16_bf16 v[64:79], v[92:95], v[156:159], v[64:79]
  s_waitcnt vmcnt(10)
  s_waitcnt lgkmcnt(0)
  ds_read_b64_tr_b16 v[88:89], v10 offset:2048
  ds_read_b64_tr_b16 v[90:91], v10 offset:2560
  ds_read_b64_tr_b16 v[92:93], v11 offset:2048
  ds_read_b64_tr_b16 v[94:95], v11 offset:2560
  v_mfma_f32_32x32x16_bf16 v[16:31], v[80:83], v[96:99], v[16:31]
  v_mfma_f32_32x32x16_bf16 v[32:47], v[84:87], v[96:99], v[32:47]
  v_mfma_f32_32x32x16_bf16 v[48:63], v[80:83], v[100:103], v[48:63]
  v_mfma_f32_32x32x16_bf16 v[64:79], v[84:87], v[100:103], v[64:79]
  s_waitcnt vmcnt(6)
  s_waitcnt lgkmcnt(0)
  ds_read_b64_tr_b16 v[80:81], v10 offset:4096
  ds_read_b64_tr_b16 v[82:83], v10 offset:4608
  ds_read_b64_tr_b16 v[84:85], v11 offset:4096
  ds_read_b64_tr_b16 v[86:87], v11 offset:4608
  v_mfma_f32_32x32x16_bf16 v[16:31], v[88:91], v[104:107], v[16:31]
  v_mfma_f32_32x32x16_bf16 v[32:47], v[92:95], v[104:107], v[32:47]
  v_mfma_f32_32x32x16_bf16 v[48:63], v[88:91], v[108:111], v[48:63]
  v_mfma_f32_32x32x16_bf16 v[64:79], v[92:95], v[108:111], v[64:79]
  s_waitcnt vmcnt(2)
  s_waitcnt lgkmcnt(0)
  ds_read_b64_tr_b16 v[88:89], v10 offset:6144
  ds_read_b64_tr_b16 v[90:91], v10 offset:6656
  ds_read_b64_tr_b16 v[92:93], v11 offset:6144
  ds_read_b64_tr_b16 v[94:95], v11 offset:6656
  v_mfma_f32_32x32x16_bf16 v[16:31], v[80:83], v[112:115], v[16:31]
  v_mfma_f32_32x32x16_bf16 v[32:47], v[84:87], v[112:115], v[32:47]
  v_mfma_f32_32x32x16_bf16 v[48:63], v[80:83], v[116:119], v[48:63]
  v_mfma_f32_32x32x16_bf16 v[64:79], v[84:87], v[116:119], v[64:79]
  s_waitcnt vmcnt(0)
  s_waitcnt lgkmcnt(0)
  v_mfma_f32_32x32x16_bf16 v[16:31], v[88:91], v[120:123], v[16:31]
  v_mfma_f32_32x32x16_bf16 v[32:47], v[92:95], v[120:123], v[32:47]
  v_mfma_f32_32x32x16_bf16 v[48:63], v[88:91], v[124:127], v[48:63]
  v_mfma_f32_32x32x16_bf16 v[64:79], v[92:95], v[124:127], v[64:79]
  v_lshlrev_b32 v2, 4, v1
  s_nop 7
  s_nop 3
  s_xor_b32 s49, s53, 1
  s_mul_i32 s49, s49, 12288
  s_add_u32 s49, s49, 65536
  v_add_u32 v3, s49, v2
  ds_write_b128 v3, v[32:35] offset:0
  ds_write_b128 v3, v[36:39] offset:1024
  ds_write_b128 v3, v[40:43] offset:2048
  ds_write_b128 v3, v[44:47] offset:3072
  s_xor_b32 s49, s53, 2
  s_mul_i32 s49, s49, 12288
  s_add_u32 s49, s49, 69632
  v_add_u32 v3, s49, v2
  ds_write_b128 v3, v[48:51] offset:0
  ds_write_b128 v3, v[52:55] offset:1024
  ds_write_b128 v3, v[56:59] offset:2048
  ds_write_b128 v3, v[60:63] offset:3072
  s_xor_b32 s49, s53, 3
  s_mul_i32 s49, s49, 12288
  s_add_u32 s49, s49, 73728
  v_add_u32 v3, s49, v2
  ds_write_b128 v3, v[64:67] offset:0
  ds_write_b128 v3, v[68:71] offset:1024
  ds_write_b128 v3, v[72:75] offset:2048
  ds_write_b128 v3, v[76:79] offset:3072
  s_mul_i32 s49, s53, 12288
  s_add_u32 s49, s49, 65536
  v_add_u32 v3, s49, v2
  s_lshl_b32 s50, s53, 4
  s_add_u32 s50, s50, 118344
  v_mov_b32 v4, s50
  v_mov_b32 v5, s35
  s_waitcnt lgkmcnt(0)
  ds_write_b32 v4, v5
  s_waitcnt lgkmcnt(0)
  s_add_u32 s36, s12, 0
  s_addc_u32 s37, s13, 0
  s_and_b32 s37, s37, 0xffff
  s_mov_b32 s38, 401408
  s_mov_b32 s39, 0x00020000
  s_add_u32 s40, s26, 11534336
  s_addc_u32 s41, s27, 0
  s_and_b32 s41, s41, 0xffff
  s_mov_b32 s42, 2097152
  s_mov_b32 s43, 0x00020000
  s_mul_i32 s44, s53, 100352
  s_lshl_b32 s49, s52, 7
  s_add_u32 s44, s44, s49
  s_add_u32 m0, s47, 0
  s_nop 0
  buffer_load_dwordx4 v8, s[36:39], s44 offen lds
  s_add_u32 m0, s47, 1024
  s_add_u32 s45, s44, 7168
  buffer_load_dwordx4 v8, s[36:39], s45 offen lds
  s_add_u32 s44, s44, 14336
  s_add_u32 m0, s47, 2048
  s_nop 0
  buffer_load_dwordx4 v8, s[36:39], s44 offen lds
  s_add_u32 m0, s47, 3072
  s_add_u32 s45, s44, 7168
  buffer_load_dwordx4 v8, s[36:39], s45 offen lds
  s_add_u32 s44, s44, 10752
  s_add_u32 m0, s47, 4096
  s_nop 0
  buffer_load_dwordx4 v8, s[36:39], s44 offen lds
  s_add_u32 m0, s47, 5120
  s_add_u32 s45, s44, 7168
  buffer_load_dwordx4 v8, s[36:39], s45 offen lds
  s_add_u32 s44, s44, 14336
  s_add_u32 m0, s47, 6144
  s_nop 0
  buffer_load_dwordx4 v8, s[36:39], s44 offen lds
  s_add_u32 m0, s47, 7168
  s_add_u32 s45, s44, 7168
  buffer_load_dwordx4 v8, s[36:39], s45 offen lds
  s_add_u32 s44, s44, 10752
  s_add_u32 m0, s47, 8192
  s_nop 0
  buffer_load_dwordx4 v8, s[36:39], s44 offen lds
  s_add_u32 m0, s47, 9216
  s_add_u32 s45, s44, 7168
  buffer_load_dwordx4 v8, s[36:39], s45 offen lds
  s_add_u32 s44, s44, 14336
  s_add_u32 m0, s47, 10240
  s_nop 0
  buffer_load_dwordx4 v8, s[36:39], s44 offen lds
  s_add_u32 m0, s47, 11264
  s_add_u32 s45, s44, 7168
  buffer_load_dwordx4 v8, s[36:39], s45 offen lds
  s_add_u32 s44, s44, 10752
  s_add_u32 m0, s47, 12288
  s_nop 0
  buffer_load_dwordx4 v8, s[36:39], s44 offen lds
  s_add_u32 m0, s47, 13312
  s_add_u32 s45, s44, 7168
  buffer_load_dwordx4 v8, s[36:39], s45 offen lds
  s_add_u32 s44, s44, 14336
  s_add_u32 m0, s47, 14336
  s_nop 0
  buffer_load_dwordx4 v8, s[36:39], s44 offen lds
  s_add_u32 m0, s47, 15360
  s_add_u32 s45, s44, 7168
  buffer_load_dwordx4 v8, s[36:39], s45 offen lds
  s_add_u32 s44, s44, 10752
  s_lshl_b32 s49, s54, 15
  v_add_u32 v12, s49, v2
  v_xor_b32 v13, 0x8000, v12
  s_lshl_b32 s46, s53, 13
  v_and_b32 v176, 31, v1
  s_lshl_b32 s49, s54, 5
  v_add_u32 v176, s49, v176
  v_mul_u32_u24 v176, 896, v176
  v_lshrrev_b32 v177, 5, v1
  v_lshl_add_u32 v176, v177, 5, v176
  s_lshl_b32 s49, s52, 1
  s_and_b32 s50, s53, 1
  s_add_u32 s49, s49, s50
  s_lshl_b32 s49, s49, 6
  v_add_u32 v176, s49, v176
  global_load_dwordx4 v[160:163], v176, s[4:5]
  global_load_dwordx4 v[164:167], v176, s[4:5] offset:16
  v_add_u32 v14, 6144, v14
  s_lshl_b32 s50, s53, 4
  s_add_u32 s50, s50, 118344
  v_mov_b32 v4, s50
  v_mov_b32 v5, s35
  v_and_b32 v6, 3, v1
  v_lshlrev_b32 v6, 4, v6
  v_add_u32 v6, 118344, v6
  s_mov_b32 s48, 3200000
L_b_sync:
  ds_read_b32 v7, v6
  s_waitcnt lgkmcnt(0)
  v_cmp_ne_u32 vcc, v7, v5
  s_sub_u32 s48, s48, 1
  s_cmp_eq_u32 s48, 0
  s_cbranch_scc1 L_b_synced
  s_cbranch_vccz L_b_synced
  s_sleep 2
  s_branch L_b_sync
L_b_synced:
  ds_read_b128 v[32:35], v3 offset:0
  ds_read_b128 v[36:39], v3 offset:1024
  ds_read_b128 v[40:43], v3 offset:2048
  ds_read_b128 v[44:47], v3 offset:3072
  ds_read_b128 v[48:51], v3 offset:4096
  ds_read_b128 v[52:55], v3 offset:5120
  ds_read_b128 v[56:59], v3 offset:6144
  ds_read_b128 v[60:63], v3 offset:7168
  ds_read_b128 v[64:67], v3 offset:8192
  ds_read_b128 v[68:71], v3 offset:9216
  ds_read_b128 v[72:75], v3 offset:10240
  ds_read_b128 v[76:79], v3 offset:11264
  s_waitcnt lgkmcnt(8)
  v_add_f32 v16, v16, v32
  v_add_f32 v17, v17, v33
  v_add_f32 v18, v18, v34
  v_add_f32 v19, v19, v35
  v_add_f32 v20, v20, v36
  v_add_f32 v21, v21, v37
  v_add_f32 v22, v22, v38
  v_add_f32 v23, v23, v39
  v_add_f32 v24, v24, v40
  v_add_f32 v25, v25, v41
  v_add_f32 v26, v26, v42
  v_add_f32 v27, v27, v43
  v_add_f32 v28, v28, v44
  v_add_f32 v29, v29, v45
  v_add_f32 v30, v30, v46
  v_add_f32 v31, v31, v47
  s_waitcnt lgkmcnt(4)
  v_add_f32 v16, v16, v48
  v_add_f32 v17, v17, v49
  v_add_f32 v18, v18, v50
  v_add_f32 v19, v19, v51
  v_add_f32 v20, v20, v52
  v_add_f32 v21, v21, v53
  v_add_f32 v22, v22, v54
  v_add_f32 v23, v23, v55
  v_add_f32 v24, v24, v56
  v_add_f32 v25, v25, v57
  v_add_f32 v26, v26, v58
  v_add_f32 v27, v27, v59
  v_add_f32 v28, v28, v60
  v_add_f32 v29, v29, v61
  v_add_f32 v30, v30, v62
  v_add_f32 v31, v31, v63
  s_waitcnt lgkmcnt(0)
  v_add_f32 v16, v16, v64
  v_add_f32 v17, v17, v65
  v_add_f32 v18, v18, v66
  v_add_f32 v19, v19, v67
  v_add_f32 v20, v20, v68
  v_add_f32 v21, v21, v69
  v_add_f32 v22, v22, v70
  v_add_f32 v23, v23, v71
  v_add_f32 v24, v24, v72
  v_add_f32 v25, v25, v73
  v_add_f32 v26, v26, v74
  v_add_f32 v27, v27, v75
  v_add_f32 v28, v28, v76
  v_add_f32 v29, v29, v77
  v_add_f32 v30, v30, v78
  v_add_f32 v31, v31, v79
  v_and_b32 v9, 0xffff0000, v9
  v_mul_f32 v9, v9, v9
  v_rcp_f32 v9, v9
  s_nop 0
  v_mul_f32 v16, v16, v9
  v_mul_f32 v17, v17, v9
  v_mul_f32 v18, v18, v9
  v_mul_f32 v19, v19, v9
  v_mul_f32 v20, v20, v9
  v_mul_f32 v21, v21, v9
  v_mul_f32 v22, v22, v9
  v_mul_f32 v23, v23, v9
  v_mul_f32 v24, v24, v9
  v_mul_f32 v25, v25, v9
  v_mul_f32 v26, v26, v9
  v_mul_f32 v27, v27, v9
  v_mul_f32 v28, v28, v9
  v_mul_f32 v29, v29, v9
  v_mul_f32 v30, v30, v9
  v_mul_f32 v31, v31, v9
  v_mul_f32 v80, 0xbfb8aa3b, v16
  v_mul_f32 v81, 0xbfb8aa3b, v17
  v_mul_f32 v82, 0xbfb8aa3b, v18
  v_mul_f32 v83, 0xbfb8aa3b, v19
  v_mul_f32 v84, 0xbfb8aa3b, v20
  v_mul_f32 v85, 0xbfb8aa3b, v21
  v_mul_f32 v86, 0xbfb8aa3b, v22
  v_mul_f32 v87, 0xbfb8aa3b, v23
  v_mul_f32 v88, 0xbfb8aa3b, v24
  v_mul_f32 v89, 0xbfb8aa3b, v25
  v_mul_f32 v90, 0xbfb8aa3b, v26
  v_mul_f32 v91, 0xbfb8aa3b, v27
  v_mul_f32 v92, 0xbfb8aa3b, v28
  v_mul_f32 v93, 0xbfb8aa3b, v29
  v_mul_f32 v94, 0xbfb8aa3b, v30
  v_mul_f32 v95, 0xbfb8aa3b, v31
  v_exp_f32 v80, v80
  v_exp_f32 v81, v81
  v_exp_f32 v82, v82
  v_exp_f32 v83, v83
  v_exp_f32 v84, v84
  v_exp_f32 v85, v85
  v_exp_f32 v86, v86
  v_exp_f32 v87, v87
  v_exp_f32 v88, v88
  v_exp_f32 v89, v89
  v_exp_f32 v90, v90
  v_exp_f32 v91, v91
  v_exp_f32 v92, v92
  v_exp_f32 v93, v93
  v_exp_f32 v94, v94
  v_exp_f32 v95, v95
  v_add_f32 v80, 1.0, v80
  v_add_f32 v81, 1.0, v81
  v_add_f32 v82, 1.0, v82
  v_add_f32 v83, 1.0, v83
  v_add_f32 v84, 1.0, v84
  v_add_f32 v85, 1.0, v85
  v_add_f32 v86, 1.0, v86
  v_add_f32 v87, 1.0, v87
  v_add_f32 v88, 1.0, v88
  v_add_f32 v89, 1.0, v89
  v_add_f32 v90, 1.0, v90
  v_add_f32 v91, 1.0, v91
  v_add_f32 v92, 1.0, v92
  v_add_f32 v93, 1.0, v93
  v_add_f32 v94, 1.0, v94
  v_add_f32 v95, 1.0, v95
  v_rcp_f32 v80, v80
  v_rcp_f32 v81, v81
  v_rcp_f32 v82, v82
  v_rcp_f32 v83, v83
  v_rcp_f32 v84, v84
  v_rcp_f32 v85, v85
  v_rcp_f32 v86, v86
  v_rcp_f32 v87, v87
  v_rcp_f32 v88, v88
  v_rcp_f32 v89, v89
  v_rcp_f32 v90, v90
  v_rcp_f32 v91, v91
  v_rcp_f32 v92, v92
  v_rcp_f32 v93, v93
  v_rcp_f32 v94, v94
  v_rcp_f32 v95, v95
  s_nop 0
  v_mul_f32 v16, v16, v80
  v_mul_f32 v17, v17, v81
  v_mul_f32 v18, v18, v82
  v_mul_f32 v19, v19, v83
  v_mul_f32 v20, v20, v84
  v_mul_f32 v21, v21, v85
  v_mul_f32 v22, v22, v86
  v_mul_f32 v23, v23, v87
  v_mul_f32 v24, v24, v88
  v_mul_f32 v25, v25, v89
  v_mul_f32 v26, v26, v90
  v_mul_f32 v27, v27, v91
  v_mul_f32 v28, v28, v92
  v_mul_f32 v29, v29, v93
  v_mul_f32 v30, v30, v94
  v_mul_f32 v31, v31, v95
  v_cvt_pk_bf16_f32 v168, v16, v17
  v_cvt_pk_bf16_f32 v169, v18, v19
  v_cvt_pk_bf16_f32 v170, v20, v21
  v_cvt_pk_bf16_f32 v171, v22, v23
  v_cvt_pk_bf16_f32 v172, v24, v25
  v_cvt_pk_bf16_f32 v173, v26, v27
  v_cvt_pk_bf16_f32 v174, v28, v29
  v_cvt_pk_bf16_f32 v175, v30, v31
  v_and_b32 v80, 1, v1
  v_bfe_u32 v81, v1, 1, 1
  v_lshl_add_u32 v80, v80, 2, v81
  v_bfe_u32 v81, v1, 2, 1
  v_lshl_add_u32 v80, v81, 4, v80
  s_lshr_b32 s49, s53, 1
  s_lshl_b32 s49, s49, 3
  s_and_b32 s50, s53, 1
  s_lshl_b32 s50, s50, 1
  s_add_u32 s49, s49, s50
  s_lshl_b32 s50, s51, 5
  s_add_u32 s49, s49, s50
  s_lshl_b32 s49, s49, 2
  s_add_u32 s49, s49, 2695168
  v_lshl_add_u32 v14, v80, 2, s49
  s_barrier
  s_mov_b32 s48, 200000
  global_load_dword v15, v14, s[26:27] sc1
L_pollo:
  s_waitcnt vmcnt(0)
  v_cmp_ne_u32 vcc, s35, v15
  s_sub_u32 s48, s48, 1
  s_cmp_eq_u32 s48, 0
  s_cbranch_scc1 L_polldo
  s_cbranch_vccz L_polldo
  global_load_dword v15, v14, s[26:27] sc1
  s_branch L_pollo
L_polldo:
  buffer_load_dwordx4 v[96:99], v12, s[40:43], s46 offen offset:0
  buffer_load_dwordx4 v[100:103], v13, s[40:43], s46 offen offset:0
  buffer_load_dwordx4 v[104:107], v12, s[40:43], s46 offen offset:1024
  buffer_load_dwordx4 v[108:111], v13, s[40:43], s46 offen offset:1024
  buffer_load_dwordx4 v[112:115], v12, s[40:43], s46 offen offset:2048
  buffer_load_dwordx4 v[116:119], v13, s[40:43], s46 offen offset:2048
  buffer_load_dwordx4 v[120:123], v12, s[40:43], s46 offen offset:3072
  buffer_load_dwordx4 v[124:127], v13, s[40:43], s46 offen offset:3072
  s_add_u32 s46, s46, 4096
  buffer_load_dwordx4 v[128:131], v12, s[40:43], s46 offen offset:0
  buffer_load_dwordx4 v[132:135], v13, s[40:43], s46 offen offset:0
  buffer_load_dwordx4 v[136:139], v12, s[40:43], s46 offen offset:1024
  buffer_load_dwordx4 v[140:143], v13, s[40:43], s46 offen offset:1024
  buffer_load_dwordx4 v[144:147], v12, s[40:43], s46 offen offset:2048
  buffer_load_dwordx4 v[148:151], v13, s[40:43], s46 offen offset:2048
  buffer_load_dwordx4 v[152:155], v12, s[40:43], s46 offen offset:3072
  buffer_load_dwordx4 v[156:159], v13, s[40:43], s46 offen offset:3072
  s_add_u32 s46, s46, 4096
  ds_read_b64_tr_b16 v[80:81], v10 offset:0
  ds_read_b64_tr_b16 v[82:83], v10 offset:512
  ds_read_b64_tr_b16 v[84:85], v11 offset:0
  ds_read_b64_tr_b16 v[86:87], v11 offset:512
  s_waitcnt vmcnt(14)
  s_waitcnt lgkmcnt(0)
  ds_read_b64_tr_b16 v[88:89], v10 offset:2048
  ds_read_b64_tr_b16 v[90:91], v10 offset:2560
  ds_read_b64_tr_b16 v[92:93], v11 offset:2048
  ds_read_b64_tr_b16 v[94:95], v11 offset:2560
  v_mfma_f32_32x32x16_bf16 v[16:31], v[80:83], v[96:99], 0
  v_mfma_f32_32x32x16_bf16 v[32:47], v[84:87], v[96:99], 0
  v_mfma_f32_32x32x16_bf16 v[48:63], v[80:83], v[100:103], 0
  v_mfma_f32_32x32x16_bf16 v[64:79], v[84:87], v[100:103], 0
  s_waitcnt vmcnt(12)
  s_waitcnt lgkmcnt(0)
  ds_read_b64_tr_b16 v[80:81], v10 offset:4096
  ds_read_b64_tr_b16 v[82:83], v10 offset:4608
  ds_read_b64_tr_b16 v[84:85], v11 offset:4096
  ds_read_b64_tr_b16 v[86:87], v11 offset:4608
  v_mfma_f32_32x32x16_bf16 v[16:31], v[88:91], v[104:107], v[16:31]
  v_mfma_f32_32x32x16_bf16 v[32:47], v[92:95], v[104:107], v[32:47]
  v_mfma_f32_32x32x16_bf16 v[48:63], v[88:91], v[108:111], v[48:63]
  v_mfma_f32_32x32x16_bf16 v[64:79], v[92:95], v[108:111], v[64:79]
  s_waitcnt vmcnt(10)
  s_waitcnt lgkmcnt(0)
  ds_read_b64_tr_b16 v[88:89], v10 offset:6144
  ds_read_b64_tr_b16 v[90:91], v10 offset:6656
  ds_read_b64_tr_b16 v[92:93], v11 offset:6144
  ds_read_b64_tr_b16 v[94:95], v11 offset:6656
  v_mfma_f32_32x32x16_bf16 v[16:31], v[80:83], v[112:115], v[16:31]
  v_mfma_f32_32x32x16_bf16 v[32:47], v[84:87], v[112:115], v[32:47]
  v_mfma_f32_32x32x16_bf16 v[48:63], v[80:83], v[116:119], v[48:63]
  v_mfma_f32_32x32x16_bf16 v[64:79], v[84:87], v[116:119], v[64:79]
  s_waitcnt vmcnt(8)
  s_waitcnt lgkmcnt(0)
  ds_read_b64_tr_b16 v[80:81], v10 offset:8192
  ds_read_b64_tr_b16 v[82:83], v10 offset:8704
  ds_read_b64_tr_b16 v[84:85], v11 offset:8192
  ds_read_b64_tr_b16 v[86:87], v11 offset:8704
  v_mfma_f32_32x32x16_bf16 v[16:31], v[88:91], v[120:123], v[16:31]
  v_mfma_f32_32x32x16_bf16 v[32:47], v[92:95], v[120:123], v[32:47]
  v_mfma_f32_32x32x16_bf16 v[48:63], v[88:91], v[124:127], v[48:63]
  v_mfma_f32_32x32x16_bf16 v[64:79], v[92:95], v[124:127], v[64:79]
  s_waitcnt vmcnt(6)
  s_waitcnt lgkmcnt(0)
  ds_read_b64_tr_b16 v[88:89], v10 offset:10240
  ds_read_b64_tr_b16 v[90:91], v10 offset:10752
  ds_read_b64_tr_b16 v[92:93], v11 offset:10240
  ds_read_b64_tr_b16 v[94:95], v11 offset:10752
  v_mfma_f32_32x32x16_bf16 v[16:31], v[80:83], v[128:131], v[16:31]
  v_mfma_f32_32x32x16_bf16 v[32:47], v[84:87], v[128:131], v[32:47]
  v_mfma_f32_32x32x16_bf16 v[48:63], v[80:83], v[132:135], v[48:63]
  v_mfma_f32_32x32x16_bf16 v[64:79], v[84:87], v[132:135], v[64:79]
  s_waitcnt vmcnt(4)
  s_waitcnt lgkmcnt(0)
  ds_read_b64_tr_b16 v[80:81], v10 offset:12288
  ds_read_b64_tr_b16 v[82:83], v10 offset:12800
  ds_read_b64_tr_b16 v[84:85], v11 offset:12288
  ds_read_b64_tr_b16 v[86:87], v11 offset:12800
  v_mfma_f32_32x32x16_bf16 v[16:31], v[88:91], v[136:139], v[16:31]
  v_mfma_f32_32x32x16_bf16 v[32:47], v[92:95], v[136:139], v[32:47]
  v_mfma_f32_32x32x16_bf16 v[48:63], v[88:91], v[140:143], v[48:63]
  v_mfma_f32_32x32x16_bf16 v[64:79], v[92:95], v[140:143], v[64:79]
  s_waitcnt vmcnt(2)
  s_waitcnt lgkmcnt(0)
  ds_read_b64_tr_b16 v[88:89], v10 offset:14336
  ds_read_b64_tr_b16 v[90:91], v10 offset:14848
  ds_read_b64_tr_b16 v[92:93], v11 offset:14336
  ds_read_b64_tr_b16 v[94:95], v11 offset:14848
  v_mfma_f32_32x32x16_bf16 v[16:31], v[80:83], v[144:147], v[16:31]
  v_mfma_f32_32x32x16_bf16 v[32:47], v[84:87], v[144:147], v[32:47]
  v_mfma_f32_32x32x16_bf16 v[48:63], v[80:83], v[148:151], v[48:63]
  v_mfma_f32_32x32x16_bf16 v[64:79], v[84:87], v[148:151], v[64:79]
  s_waitcnt vmcnt(0)
  s_waitcnt lgkmcnt(0)
  v_mfma_f32_32x32x16_bf16 v[16:31], v[88:91], v[152:155], v[16:31]
  v_mfma_f32_32x32x16_bf16 v[32:47], v[92:95], v[152:155], v[32:47]
  v_mfma_f32_32x32x16_bf16 v[48:63], v[88:91], v[156:159], v[48:63]
  v_mfma_f32_32x32x16_bf16 v[64:79], v[92:95], v[156:159], v[64:79]
  v_add_u32 v3, s47, v2
  s_nop 7
  s_nop 3
  ds_write_b128 v3, v[32:35] offset:0
  ds_write_b128 v3, v[36:39] offset:1024
  ds_write_b128 v3, v[40:43] offset:2048
  ds_write_b128 v3, v[44:47] offset:3072
  ds_write_b128 v3, v[48:51] offset:4096
  ds_write_b128 v3, v[52:55] offset:5120
  ds_write_b128 v3, v[56:59] offset:6144
  ds_write_b128 v3, v[60:63] offset:7168
  ds_write_b128 v3, v[64:67] offset:8192
  ds_write_b128 v3, v[68:71] offset:9216
  ds_write_b128 v3, v[72:75] offset:10240
  ds_write_b128 v3, v[76:79] offset:11264
  s_waitcnt lgkmcnt(0)
  s_barrier
  v_xor_b32 v4, 16384, v3
  ds_read_b128 v[32:35], v4 offset:0
  ds_read_b128 v[36:39], v4 offset:1024
  ds_read_b128 v[40:43], v4 offset:2048
  ds_read_b128 v[44:47], v4 offset:3072
  v_xor_b32 v4, 32768, v3
  ds_read_b128 v[48:51], v4 offset:4096
  ds_read_b128 v[52:55], v4 offset:5120
  ds_read_b128 v[56:59], v4 offset:6144
  ds_read_b128 v[60:63], v4 offset:7168
  v_xor_b32 v4, 49152, v3
  ds_read_b128 v[64:67], v4 offset:8192
  ds_read_b128 v[68:71], v4 offset:9216
  ds_read_b128 v[72:75], v4 offset:10240
  ds_read_b128 v[76:79], v4 offset:11264
  s_waitcnt lgkmcnt(8)
  v_add_f32 v16, v16, v32
  v_add_f32 v17, v17, v33
  v_add_f32 v18, v18, v34
  v_add_f32 v19, v19, v35
  v_add_f32 v20, v20, v36
  v_add_f32 v21, v21, v37
  v_add_f32 v22, v22, v38
  v_add_f32 v23, v23, v39
  v_add_f32 v24, v24, v40
  v_add_f32 v25, v25, v41
  v_add_f32 v26, v26, v42
  v_add_f32 v27, v27, v43
  v_add_f32 v28, v28, v44
  v_add_f32 v29, v29, v45
  v_add_f32 v30, v30, v46
  v_add_f32 v31, v31, v47
  s_waitcnt lgkmcnt(4)
  v_add_f32 v16, v16, v48
  v_add_f32 v17, v17, v49
  v_add_f32 v18, v18, v50
  v_add_f32 v19, v19, v51
  v_add_f32 v20, v20, v52
  v_add_f32 v21, v21, v53
  v_add_f32 v22, v22, v54
  v_add_f32 v23, v23, v55
  v_add_f32 v24, v24, v56
  v_add_f32 v25, v25, v57
  v_add_f32 v26, v26, v58
  v_add_f32 v27, v27, v59
  v_add_f32 v28, v28, v60
  v_add_f32 v29, v29, v61
  v_add_f32 v30, v30, v62
  v_add_f32 v31, v31, v63
  s_waitcnt lgkmcnt(0)
  v_add_f32 v16, v16, v64
  v_add_f32 v17, v17, v65
  v_add_f32 v18, v18, v66
  v_add_f32 v19, v19, v67
  v_add_f32 v20, v20, v68
  v_add_f32 v21, v21, v69
  v_add_f32 v22, v22, v70
  v_add_f32 v23, v23, v71
  v_add_f32 v24, v24, v72
  v_add_f32 v25, v25, v73
  v_add_f32 v26, v26, v74
  v_add_f32 v27, v27, v75
  v_add_f32 v28, v28, v76
  v_add_f32 v29, v29, v77
  v_add_f32 v30, v30, v78
  v_add_f32 v31, v31, v79
  v_lshlrev_b32 v80, 16, v160
  v_and_b32 v81, 0xffff0000, v160
  v_lshlrev_b32 v82, 16, v168
  v_and_b32 v83, 0xffff0000, v168
  v_fmac_f32 v80, v16, v82
  v_fmac_f32 v81, v17, v83
  v_cvt_pk_bf16_f32 v88, v80, v81
  v_lshlrev_b32 v80, 16, v161
  v_and_b32 v81, 0xffff0000, v161
  v_lshlrev_b32 v82, 16, v169
  v_and_b32 v83, 0xffff0000, v169
  v_fmac_f32 v80, v18, v82
  v_fmac_f32 v81, v19, v83
  v_cvt_pk_bf16_f32 v89, v80, v81
  v_lshlrev_b32 v80, 16, v162
  v_and_b32 v81, 0xffff0000, v162
  v_lshlrev_b32 v82, 16, v170
  v_and_b32 v83, 0xffff0000, v170
  v_fmac_f32 v80, v20, v82
  v_fmac_f32 v81, v21, v83
  v_cvt_pk_bf16_f32 v90, v80, v81
  v_lshlrev_b32 v80, 16, v163
  v_and_b32 v81, 0xffff0000, v163
  v_lshlrev_b32 v82, 16, v171
  v_and_b32 v83, 0xffff0000, v171
  v_fmac_f32 v80, v22, v82
  v_fmac_f32 v81, v23, v83
  v_cvt_pk_bf16_f32 v91, v80, v81
  v_lshlrev_b32 v80, 16, v164
  v_and_b32 v81, 0xffff0000, v164
  v_lshlrev_b32 v82, 16, v172
  v_and_b32 v83, 0xffff0000, v172
  v_fmac_f32 v80, v24, v82
  v_fmac_f32 v81, v25, v83
  v_cvt_pk_bf16_f32 v92, v80, v81
  v_lshlrev_b32 v80, 16, v165
  v_and_b32 v81, 0xffff0000, v165
  v_lshlrev_b32 v82, 16, v173
  v_and_b32 v83, 0xffff0000, v173
  v_fmac_f32 v80, v26, v82
  v_fmac_f32 v81, v27, v83
  v_cvt_pk_bf16_f32 v93, v80, v81
  v_lshlrev_b32 v80, 16, v166
  v_and_b32 v81, 0xffff0000, v166
  v_lshlrev_b32 v82, 16, v174
  v_and_b32 v83, 0xffff0000, v174
  v_fmac_f32 v80, v28, v82
  v_fmac_f32 v81, v29, v83
  v_cvt_pk_bf16_f32 v94, v80, v81
  v_lshlrev_b32 v80, 16, v167
  v_and_b32 v81, 0xffff0000, v167
  v_lshlrev_b32 v82, 16, v175
  v_and_b32 v83, 0xffff0000, v175
  v_fmac_f32 v80, v30, v82
  v_fmac_f32 v81, v31, v83
  v_cvt_pk_bf16_f32 v95, v80, v81
  global_store_dwordx4 v176, v[88:91], s[22:23]
  global_store_dwordx4 v176, v[92:95], s[22:23] offset:16
L_end:
  s_endpgm
L_compute:
  v_mov_b32 v32, 0
  v_mov_b32 v33, 0
  v_mov_b32 v34, 0
  v_mov_b32 v35, 0
  v_mov_b32 v36, 0
  v_mov_b32 v37, 0
  v_mov_b32 v38, 0
  v_mov_b32 v39, 0
  s_lshl_b32 s31, s28, 7
  s_lshl_b32 s32, s29, 3
  s_add_u32 s31, s31, s32
  s_lshl_b32 s32, s30, 1
  s_add_u32 s31, s31, s32
  s_mul_i32 s31, s31, 896
  v_lshlrev_b32 v16, 4, v1
  v_add_u32 v16, s31, v16
  s_waitcnt lgkmcnt(0)
  s_mov_b32 exec_hi, 0x00ffffff
  global_load_dwordx4 v[32:35], v16, s[4:5]
  global_load_dwordx4 v[36:39], v16, s[4:5] offset:896
  s_mov_b64 exec, -1
  s_getpc_b64 s[74:75]
L_pc:
  s_sub_u32 s74, s74, L_pc-L_pc0
  s_subb_u32 s75, s75, 0
  s_lshr_b32 s31, s2, 3
  s_lshl_b32 s31, s31, 2
  s_add_u32 s31, s31, s30
  s_lshl_b32 s31, s31, 8
  v_and_b32 v250, 1, v1
  v_lshl_add_u32 v250, v250, 7, s31
  v_min_u32 v250, L_last-L_pc0, v250
  s_mov_b64 exec, 3
  global_load_dword v251, v250, s[74:75]
  s_mov_b64 exec, -1
  v_bfe_u32 v16, v1, 2, 2
  v_lshrrev_b32 v17, 5, v1
  v_bfe_u32 v18, v1, 4, 1
  v_and_b32 v19, 1, v1
  v_bfe_u32 v20, v1, 1, 1
  v_bfe_u32 v21, v1, 3, 1
  v_lshlrev_b32 v22, 3, v20
  v_add_u32 v22, 114688, v22
  v_lshl_add_u32 v23, v16, 7, v22
  v_lshl_add_u32 v23, v17, 11, v23
  s_and_b32 s31, s30, 2
  v_lshl_add_u32 v24, v18, 10, v23
  v_lshl_add_u32 v24, v19, 4, v24
  v_lshl_add_u32 v25, v18, 1, v21
  v_xor_b32 v25, s31, v25
  v_lshl_add_u32 v4, v25, 5, v24
  v_xor_b32 v5, 32, v4
  v_mov_b32 v2, v4
  v_mov_b32 v3, v5
  s_cmp_ge_u32 s29, 4
  s_cbranch_scc1 L_p1c_go
  s_lshl_b32 s32, s29, 2
  s_add_u32 s32, s32, s31
  s_cmp_eq_u32 s32, 14
  s_cbranch_scc1 L_p1c_kvs
  s_lshl_b32 s32, s31, 9
  v_add_u32 v24, s32, v23
  v_lshl_add_u32 v24, v18, 4, v24
  v_lshl_add_u32 v24, v19, 5, v24
  v_lshl_add_u32 v2, v21, 6, v24
  v_xor_b32 v3, 64, v2
  s_branch L_p1c_go
L_p1c_kvs:
  v_lshl_add_u32 v24, v16, 6, v22
  v_lshl_add_u32 v24, v17, 9, v24
  v_lshl_add_u32 v24, v19, 5, v24
  v_lshl_add_u32 v24, v18, 4, v24
  v_and_b32 v25, 19, v1
  v_cmp_eq_u32 vcc, 17, v25
  v_add_u32 v25, 1024, v24
  v_add_u32 v26, 1032, v24
  v_cndmask_b32 v2, v25, v26, vcc
  v_add_u32 v3, 2048, v2
L_p1c_go:
  v_and_b32 v16, 31, v1
  v_lshlrev_b32 v16, 7, v16
  s_and_b32 s32, s30, 1
  s_lshl_b32 s32, s32, 13
  v_add_u32 v16, s32, v16
  v_bfe_u32 v18, v1, 1, 3
  v_xor_b32 v17, v17, v18
  v_xor_b32 v18, 0, v17
  v_lshl_add_u32 v6, v18, 4, v16
  v_xor_b32 v18, 2, v17
  v_lshl_add_u32 v7, v18, 4, v16
  v_xor_b32 v18, 4, v17
  v_lshl_add_u32 v8, v18, 4, v16
  v_xor_b32 v18, 6, v17
  v_lshl_add_u32 v9, v18, 4, v16
  s_lshl_b32 s39, s28, 2
  s_and_b32 s32, s30, 1
  s_lshl_b32 s32, s32, 1
  s_add_u32 s39, s39, s32
  v_lshlrev_b32 v16, 4, v1
  v_and_b32 v20, 31, v1
  v_lshrrev_b32 v21, 5, v1
  v_lshlrev_b32 v22, 4, v20
  v_lshl_add_u32 v22, v21, 10, v22
  s_lshl_b32 s31, s39, 8
  s_add_u32 s31, s31, 2621440
  v_lshl_add_u32 v23, v20, 3, s31
  s_and_b32 s31, s30, 2
  s_lshl_b32 s31, s31, 8
  s_lshl_b32 s32, s29, 14
  s_add_u32 s32, s32, s31
  s_add_u32 s32, s32, 3149824
  v_lshl_add_u32 v12, v1, 3, s32
  v_add_u32 v13, 8192, v12
  s_lshl_b32 s32, s29, 8
  s_add_u32 s32, s32, 2703360
  v_lshl_add_u32 v14, v1, 2, s32
  v_mov_b32 v28, 98304
  s_mov_b32 s40, 16384
  s_mov_b32 s41, 4294934528
  s_mov_b32 s37, 0
  s_mov_b32 s38, 0
  s_mov_b32 s42, 0
  s_cmp_lt_u32 s29, 4
  s_cselect_b32 s46, 7, 99
  v_mov_b32 v64, 0
  v_mov_b32 v65, 0
  v_mov_b32 v66, 0
  v_mov_b32 v67, 0
  v_mov_b32 v68, 0
  v_mov_b32 v69, 0
  v_mov_b32 v70, 0
  v_mov_b32 v71, 0
  v_mov_b32 v72, 0
  v_mov_b32 v73, 0
  v_mov_b32 v74, 0
  v_mov_b32 v75, 0
  v_mov_b32 v76, 0
  v_mov_b32 v77, 0
  v_mov_b32 v78, 0
  v_mov_b32 v79, 0
  v_mov_b32 v80, 0
  v_mov_b32 v81, 0
  v_mov_b32 v82, 0
  v_mov_b32 v83, 0
  v_mov_b32 v84, 0
  v_mov_b32 v85, 0
  v_mov_b32 v86, 0
  v_mov_b32 v87, 0
  v_mov_b32 v88, 0
  v_mov_b32 v89, 0
  v_mov_b32 v90, 0
  v_mov_b32 v91, 0
  v_mov_b32 v92, 0
  v_mov_b32 v93, 0
  v_mov_b32 v94, 0
  v_mov_b32 v95, 0
  v_mov_b32 v96, 0
  v_mov_b32 v97, 0
  v_mov_b32 v98, 0
  v_mov_b32 v99, 0
  v_mov_b32 v100, 0
  v_mov_b32 v101, 0
  v_mov_b32 v102, 0
  v_mov_b32 v103, 0
  v_mov_b32 v104, 0
  v_mov_b32 v105, 0
  v_mov_b32 v106, 0
  v_mov_b32 v107, 0
  v_mov_b32 v108, 0
  v_mov_b32 v109, 0
  v_mov_b32 v110, 0
  v_mov_b32 v111, 0
  v_mov_b32 v112, 0
  v_mov_b32 v113, 0
  v_mov_b32 v114, 0
  v_mov_b32 v115, 0
  v_mov_b32 v116, 0
  v_mov_b32 v117, 0
  v_mov_b32 v118, 0
  v_mov_b32 v119, 0
  v_mov_b32 v120, 0
  v_mov_b32 v121, 0
  v_mov_b32 v122, 0
  v_mov_b32 v123, 0
  v_mov_b32 v124, 0
  v_mov_b32 v125, 0
  v_mov_b32 v126, 0
  v_mov_b32 v127, 0
  s_mov_b32 s31, 0x3f803f80
  s_mov_b32 s32, 0xffff0000
  v_mov_b32 v48, 0
  v_mov_b32 v49, 0
  v_mov_b32 v50, 0
  v_mov_b32 v51, 0
  s_waitcnt vmcnt(0)
  v_dot2_f32_bf16 v49, v32, v32, v49
  v_dot2_f32_bf16 v48, v32, s31, v48
  v_dot2_f32_bf16 v51, v36, v36, v51
  v_dot2_f32_bf16 v50, v36, s31, v50
  v_dot2_f32_bf16 v49, v33, v33, v49
  v_dot2_f32_bf16 v48, v33, s31, v48
  v_dot2_f32_bf16 v51, v37, v37, v51
  v_dot2_f32_bf16 v50, v37, s31, v50
  v_dot2_f32_bf16 v49, v34, v34, v49
  v_dot2_f32_bf16 v48, v34, s31, v48
  v_dot2_f32_bf16 v51, v38, v38, v51
  v_dot2_f32_bf16 v50, v38, s31, v50
  v_dot2_f32_bf16 v49, v35, v35, v49
  v_dot2_f32_bf16 v48, v35, s31, v48
  v_dot2_f32_bf16 v51, v39, v39, v51
  v_dot2_f32_bf16 v50, v39, s31, v50
  s_nop 2
  v_add_f32_dpp v48, v48, v48 quad_perm:[1,0,3,2] row_mask:0xf bank_mask:0xf
  v_add_f32_dpp v49, v49, v49 quad_perm:[1,0,3,2] row_mask:0xf bank_mask:0xf
  v_add_f32_dpp v50, v50, v50 quad_perm:[1,0,3,2] row_mask:0xf bank_mask:0xf
  v_add_f32_dpp v51, v51, v51 quad_perm:[1,0,3,2] row_mask:0xf bank_mask:0xf
  v_add_f32_dpp v48, v48, v48 quad_perm:[2,3,0,1] row_mask:0xf bank_mask:0xf
  v_add_f32_dpp v49, v49, v49 quad_perm:[2,3,0,1] row_mask:0xf bank_mask:0xf
  v_add_f32_dpp v50, v50, v50 quad_perm:[2,3,0,1] row_mask:0xf bank_mask:0xf
  v_add_f32_dpp v51, v51, v51 quad_perm:[2,3,0,1] row_mask:0xf bank_mask:0xf
  v_add_f32_dpp v48, v48, v48 row_half_mirror row_mask:0xf bank_mask:0xf
  v_add_f32_dpp v49, v49, v49 row_half_mirror row_mask:0xf bank_mask:0xf
  v_add_f32_dpp v50, v50, v50 row_half_mirror row_mask:0xf bank_mask:0xf
  v_add_f32_dpp v51, v51, v51 row_half_mirror row_mask:0xf bank_mask:0xf
  v_add_f32_dpp v48, v48, v48 row_mirror row_mask:0xf bank_mask:0xf
  v_add_f32_dpp v49, v49, v49 row_mirror row_mask:0xf bank_mask:0xf
  v_add_f32_dpp v50, v50, v50 row_mirror row_mask:0xf bank_mask:0xf
  v_add_f32_dpp v51, v51, v51 row_mirror row_mask:0xf bank_mask:0xf
  v_mov_b32 v52, v48
  v_mov_b32 v53, v49
  v_mov_b32 v54, v50
  v_mov_b32 v55, v51
  s_nop 1
  v_permlane16_swap_b32 v48, v52
  v_permlane16_swap_b32 v49, v53
  v_permlane16_swap_b32 v50, v54
  v_permlane16_swap_b32 v51, v55
  s_nop 1
  v_add_f32 v48, v48, v52
  v_add_f32 v49, v49, v53
  v_add_f32 v50, v50, v54
  v_add_f32 v51, v51, v55
  v_mov_b32 v52, v48
  v_mov_b32 v53, v49
  v_mov_b32 v54, v50
  v_mov_b32 v55, v51
  s_nop 1
  v_permlane32_swap_b32 v48, v52
  v_permlane32_swap_b32 v49, v53
  v_permlane32_swap_b32 v50, v54
  v_permlane32_swap_b32 v51, v55
  s_nop 1
  v_add_f32 v48, v48, v52
  v_add_f32 v49, v49, v53
  v_add_f32 v50, v50, v54
  v_add_f32 v51, v51, v55
  v_cmp_eq_u32 vcc, 1, v1
  s_nop 1
  v_cndmask_b32 v48, v48, v50, vcc
  v_cndmask_b32 v49, v49, v51, vcc
  v_mul_f32 v48, 0x3b124925, v48
  v_mul_f32 v49, 0x3b124925, v49
  v_fma_f32 v49, -v48, v48, v49
  v_max_f32 v49, 0, v49
  v_cvt_pk_bf16_f32 v49, v49, v49
  v_and_b32 v49, s32, v49
  v_add_f32 v49, 0x3727c5ac, v49
  v_cvt_pk_bf16_f32 v49, v49, v49
  v_and_b32 v49, s32, v49
  v_sqrt_f32 v49, v49
  s_lshl_b32 s31, s28, 4
  v_cvt_pk_bf16_f32 v240, v48, v49
  s_add_u32 s31, s31, s29
  s_lshl_b32 s31, s31, 2
  s_add_u32 s31, s31, s30
  s_lshl_b32 s31, s31, 4
  s_add_u32 s31, s31, 2621440
  v_lshl_add_u32 v242, v1, 3, s31
  v_mov_b32 v204, 0
  v_mov_b32 v205, 0
  v_mov_b32 v206, 0
  v_mov_b32 v207, 0
  v_lshrrev_b32 v56, 3, v1
  v_and_b32 v57, 7, v1
  s_and_b32 s32, s30, 1
  s_cmp_eq_u32 s32, 0
  s_cselect_b32 s64, s16, s18
  s_cselect_b32 s65, s17, s19
  s_add_u32 s31, s29, 12
  s_sub_u32 s33, s29, 4
  s_cmp_ge_u32 s30, 2
  s_cselect_b32 s31, s31, s33
  s_movk_i32 s33, 3584
  s_mov_b32 s66, 0
  s_cbranch_scc1 L_p1c_cs0
  s_cmp_ge_u32 s29, 4
  s_cbranch_scc1 L_p1c_cs0
  s_mov_b32 s64, s6
  s_mov_b32 s65, s7
  s_lshl_b32 s31, s29, 1
  s_add_u32 s31, s31, s32
  s_movk_i32 s33, 896
  s_mov_b32 s66, 1
  s_cmp_lg_u32 s31, 7
  s_cbranch_scc1 L_p1c_cs0
  s_mov_b32 s66, 2
  s_mul_i32 s31, s28, 1568
  v_mul_u32_u24 v58, 56, v56
  v_and_b32 v59, 3, v1
  v_lshlrev_b32 v59, 4, v59
  v_min_u32 v59, 40, v59
  v_add3_u32 v58, v58, v59, s31
  s_mov_b32 exec_lo, 0xf0f0f0f
  s_mov_b32 exec_hi, 0xf0f0f0f
  global_load_dwordx4 v[192:195], v58, s[8:9] offset:0
  s_mov_b32 exec_lo, 0xf0f0f0f0
  s_mov_b32 exec_hi, 0xf0f0f0f0
  global_load_dwordx4 v[192:195], v58, s[10:11] offset:0
  s_mov_b32 exec_lo, 0xf0f0f0f
  s_mov_b32 exec_hi, 0xf0f0f0f
  global_load_dwordx4 v[196:199], v58, s[8:9] offset:448
  s_mov_b32 exec_lo, 0xf0f0f0f0
  s_mov_b32 exec_hi, 0xf0f0f0f0
  global_load_dwordx4 v[196:199], v58, s[10:11] offset:448
  s_mov_b32 exec_lo, 0xf0f0f0f
  s_mov_b32 exec_hi, 0xf0f0f0f
  global_load_dwordx4 v[200:203], v58, s[8:9] offset:896
  s_mov_b32 exec_lo, 0xf0f0f0f0
  s_mov_b32 exec_hi, 0xf0f0f0f0
  global_load_dwordx4 v[200:203], v58, s[10:11] offset:896
  s_mov_b32 exec_lo, 0xf0f0f0f
  s_mov_b32 exec_hi, 0
  global_load_dwordx4 v[204:207], v58, s[8:9] offset:1344
  s_mov_b32 exec_lo, 0xf0f0f0f0
  s_mov_b32 exec_hi, 0
  global_load_dwordx4 v[204:207], v58, s[10:11] offset:1344
  s_mov_b64 exec, -1
  s_branch L_p1c_cs1
L_p1c_cs0:
  s_lshl_b32 s31, s31, 7
  s_mul_i32 s32, s28, 28
  v_add_u32 v58, s32, v56
  v_mul_lo_u32 v58, v58, s33
  v_lshl_add_u32 v58, v57, 4, v58
  v_add_u32 v58, s31, v58
  s_lshl_b32 s33, s33, 3
  global_load_dwordx4 v[192:195], v58, s[64:65]
  v_add_u32 v58, s33, v58
  global_load_dwordx4 v[196:199], v58, s[64:65]
  v_add_u32 v58, s33, v58
  global_load_dwordx4 v[200:203], v58, s[64:65]
  v_add_u32 v58, s33, v58
  s_mov_b32 exec_hi, 0
  global_load_dwordx4 v[204:207], v58, s[64:65]
  s_mov_b64 exec, -1
L_p1c_cs1:
  v_lshl_add_u32 v58, v57, 3, v56
  s_and_b32 s32, s30, 1
  s_cmp_eq_u32 s66, 0
  s_cbranch_scc1 L_p1c_pg
  v_and_b32 v59, 24, v58
  v_cmp_eq_u32 vcc, 24, v59
  s_and_b32 s31, s66, 2
  s_lshl_b32 s31, s31, 1
  v_xor_b32 v59, s31, v58
  v_cndmask_b32 v58, v58, v59, vcc
  v_and_b32 v59, 0x23, v58
  v_bfe_u32 v60, v58, 4, 1
  v_lshl_add_u32 v59, v60, 2, v59
  v_bfe_u32 v60, v58, 2, 2
  v_lshl_add_u32 v59, v60, 3, v59
  s_lshl_b32 s32, s32, 6
  s_branch L_p1c_pa
L_p1c_pg:
  v_and_b32 v59, 3, v58
  v_bfe_u32 v60, v58, 3, 1
  v_lshl_add_u32 v59, v60, 2, v59
  v_bfe_u32 v60, v58, 2, 1
  v_lshl_add_u32 v59, v60, 3, v59
  v_lshrrev_b32 v60, 4, v58
  v_lshl_add_u32 v59, v60, 5, v59
  s_lshl_b32 s32, s32, 4
L_p1c_pa:
  v_add_u32 v59, s32, v59
  s_lshl_b32 s32, s29, 4
  s_add_u32 s32, s32, s28
  s_lshl_b32 s31, s32, 2
  s_add_u32 s31, s31, s30
  s_lshl_b32 s31, s31, 2
  s_add_u32 s31, s31, 2703360
  v_mov_b32 v244, s31
  s_lshl_b32 s32, s32, 8
  s_lshr_b32 s31, s30, 1
  s_add_u32 s32, s32, s31
  s_lshl_b32 s32, s32, 2
  s_add_u32 s32, s32, 3145728
  v_lshl_add_u32 v208, v59, 3, s32
  v_bfe_u32 v60, v1, 3, 1
  v_cmp_eq_u32 s[68:69], 1, v60
  v_bfe_u32 v60, v1, 4, 1
  v_cmp_eq_u32 s[70:71], 1, v60
  v_bfe_u32 v60, v1, 5, 1
  v_cmp_eq_u32 s[72:73], 1, v60
  s_waitcnt lgkmcnt(0)
  s_barrier
  s_lshl_b32 s32, s29, 2
  s_and_b32 s31, s30, 2
  s_add_u32 s32, s32, s31
  s_cmp_eq_u32 s32, 14
  s_cbranch_scc0 L_p1c_passa
  ds_read_b128 v[48:51], v6 offset:0
  ds_read_b128 v[52:55], v6 offset:4096
  ds_read_b64_tr_b16 v[32:33], v2 offset:0
  ds_read_b64_tr_b16 v[34:35], v2 offset:256
  ds_read_b64_tr_b16 v[36:37], v3 offset:0
  ds_read_b64_tr_b16 v[38:39], v3 offset:256
  v_add_u32 v6, s40, v6
  s_mov_b32 s36, 7
L_p1c_loopv:
  s_waitcnt lgkmcnt(0)
  v_mfma_f32_32x32x16_bf16 v[64:79], v[32:35], v[48:51], v[64:79]
  ds_read_b128 v[56:59], v7 offset:0
  ds_read_b128 v[60:63], v7 offset:4096
  ds_read_b64_tr_b16 v[40:41], v2 offset:4096
  v_mfma_f32_32x32x16_bf16 v[80:95], v[48:51], v[36:39], v[80:95]
  ds_read_b64_tr_b16 v[42:43], v2 offset:4352
  ds_read_b64_tr_b16 v[44:45], v3 offset:4096
  ds_read_b64_tr_b16 v[46:47], v3 offset:4352
  v_mfma_f32_32x32x16_bf16 v[96:111], v[32:35], v[52:55], v[96:111]
  v_add_u32 v7, s40, v7
  s_set_gpr_idx_on s42, gpr_idx(DST)
  v_mov_b32 v128, 0
  v_mov_b32 v129, 0
  v_mov_b32 v130, 0
  s_set_gpr_idx_off
  v_mfma_f32_32x32x16_bf16 v[112:127], v[52:55], v[36:39], v[112:127]
  s_set_gpr_idx_on s42, gpr_idx(DST)
  v_mov_b32 v131, 0
  v_mov_b32 v132, 0
  v_mov_b32 v133, 0
  s_set_gpr_idx_off
  s_waitcnt lgkmcnt(0)
  v_mfma_f32_32x32x16_bf16 v[64:79], v[40:43], v[56:59], v[64:79]
  ds_read_b128 v[48:51], v8 offset:0
  ds_read_b128 v[52:55], v8 offset:4096
  ds_read_b64_tr_b16 v[32:33], v2 offset:8192
  v_mfma_f32_32x32x16_bf16 v[80:95], v[56:59], v[44:47], v[80:95]
  ds_read_b64_tr_b16 v[34:35], v2 offset:8448
  ds_read_b64_tr_b16 v[36:37], v3 offset:8192
  ds_read_b64_tr_b16 v[38:39], v3 offset:8448
  v_mfma_f32_32x32x16_bf16 v[96:111], v[40:43], v[60:63], v[96:111]
  v_add_u32 v8, s40, v8
  s_set_gpr_idx_on s42, gpr_idx(DST)
  v_mov_b32 v134, 0
  v_mov_b32 v135, 0
  s_set_gpr_idx_off
  v_mfma_f32_32x32x16_bf16 v[112:127], v[60:63], v[44:47], v[112:127]
  s_set_gpr_idx_on s42, gpr_idx(DST)
  v_mov_b32 v136, 0
  v_mov_b32 v137, 0
  s_set_gpr_idx_off
  s_add_u32 s42, s42, 9
  s_waitcnt lgkmcnt(0)
  v_mfma_f32_32x32x16_bf16 v[64:79], v[32:35], v[48:51], v[64:79]
  ds_read_b128 v[56:59], v9 offset:0
  ds_read_b128 v[60:63], v9 offset:4096
  ds_read_b64_tr_b16 v[40:41], v2 offset:12288
  v_mfma_f32_32x32x16_bf16 v[80:95], v[48:51], v[36:39], v[80:95]
  ds_read_b64_tr_b16 v[42:43], v2 offset:12544
  ds_read_b64_tr_b16 v[44:45], v3 offset:12288
  ds_read_b64_tr_b16 v[46:47], v3 offset:12544
  v_mfma_f32_32x32x16_bf16 v[96:111], v[32:35], v[52:55], v[96:111]
  v_add_u32 v9, s40, v9
  s_add_u32 s37, s37, 1
  s_cmp_eq_u32 s37, 3
  s_cselect_b32 s31, s41, s40
  s_cselect_b32 s37, 0, s37
  v_mfma_f32_32x32x16_bf16 v[112:127], v[52:55], v[36:39], v[112:127]
  v_add_u32 v2, s31, v2
  v_add_u32 v3, s31, v3
  s_waitcnt lgkmcnt(0)
  s_barrier
  v_mfma_f32_32x32x16_bf16 v[64:79], v[40:43], v[56:59], v[64:79]
  ds_read_b128 v[48:51], v6 offset:0
  ds_read_b128 v[52:55], v6 offset:4096
  ds_read_b64_tr_b16 v[32:33], v2 offset:0
  v_mfma_f32_32x32x16_bf16 v[80:95], v[56:59], v[44:47], v[80:95]
  ds_read_b64_tr_b16 v[34:35], v2 offset:256
  ds_read_b64_tr_b16 v[36:37], v3 offset:0
  ds_read_b64_tr_b16 v[38:39], v3 offset:256
  v_mfma_f32_32x32x16_bf16 v[96:111], v[40:43], v[60:63], v[96:111]
  v_add_u32 v6, s40, v6
  v_mfma_f32_32x32x16_bf16 v[112:127], v[60:63], v[44:47], v[112:127]
  s_getpc_b64 s[44:45]
  s_branch L_p1c_hook
  s_sub_u32 s36, s36, 1
  s_cmp_lg_u32 s36, 0
  s_cbranch_scc1 L_p1c_loopv
  s_branch L_p1c_mid
L_p1c_passa:
  ds_read_b128 v[48:51], v6 offset:0
  ds_read_b128 v[52:55], v6 offset:4096
  ds_read_b64_tr_b16 v[32:33], v2 offset:0
  ds_read_b64_tr_b16 v[34:35], v2 offset:512
  ds_read_b64_tr_b16 v[36:37], v3 offset:0
  ds_read_b64_tr_b16 v[38:39], v3 offset:512
  v_add_u32 v6, s40, v6
  s_mov_b32 s36, 7
L_p1c_loopa:
  s_waitcnt lgkmcnt(0)
  v_mfma_f32_32x32x16_bf16 v[64:79], v[32:35], v[48:51], v[64:79]
  ds_read_b128 v[56:59], v7 offset:0
  ds_read_b128 v[60:63], v7 offset:4096
  ds_read_b64_tr_b16 v[40:41], v2 offset:4096
  v_mfma_f32_32x32x16_bf16 v[80:95], v[36:39], v[48:51], v[80:95]
  ds_read_b64_tr_b16 v[42:43], v2 offset:4608
  ds_read_b64_tr_b16 v[44:45], v3 offset:4096
  ds_read_b64_tr_b16 v[46:47], v3 offset:4608
  v_mfma_f32_32x32x16_bf16 v[96:111], v[32:35], v[52:55], v[96:111]
  v_add_u32 v7, s40, v7
  s_set_gpr_idx_on s42, gpr_idx(DST)
  v_mov_b32 v128, 0
  v_mov_b32 v129, 0
  v_mov_b32 v130, 0
  s_set_gpr_idx_off
  v_mfma_f32_32x32x16_bf16 v[112:127], v[36:39], v[52:55], v[112:127]
  s_set_gpr_idx_on s42, gpr_idx(DST)
  v_mov_b32 v131, 0
  v_mov_b32 v132, 0
  v_mov_b32 v133, 0
  s_set_gpr_idx_off
  s_waitcnt lgkmcnt(0)
  v_mfma_f32_32x32x16_bf16 v[64:79], v[40:43], v[56:59], v[64:79]
  ds_read_b128 v[48:51], v8 offset:0
  ds_read_b128 v[52:55], v8 offset:4096
  ds_read_b64_tr_b16 v[32:33], v2 offset:8192
  v_mfma_f32_32x32x16_bf16 v[80:95], v[44:47], v[56:59], v[80:95]
  ds_read_b64_tr_b16 v[34:35], v2 offset:8704
  ds_read_b64_tr_b16 v[36:37], v3 offset:8192
  ds_read_b64_tr_b16 v[38:39], v3 offset:8704
  v_mfma_f32_32x32x16_bf16 v[96:111], v[40:43], v[60:63], v[96:111]
  v_add_u32 v8, s40, v8
  s_set_gpr_idx_on s42, gpr_idx(DST)
  v_mov_b32 v134, 0
  v_mov_b32 v135, 0
  s_set_gpr_idx_off
  v_mfma_f32_32x32x16_bf16 v[112:127], v[44:47], v[60:63], v[112:127]
  s_set_gpr_idx_on s42, gpr_idx(DST)
  v_mov_b32 v136, 0
  v_mov_b32 v137, 0
  s_set_gpr_idx_off
  s_add_u32 s42, s42, 9
  s_waitcnt lgkmcnt(0)
  v_mfma_f32_32x32x16_bf16 v[64:79], v[32:35], v[48:51], v[64:79]
  ds_read_b128 v[56:59], v9 offset:0
  ds_read_b128 v[60:63], v9 offset:4096
  ds_read_b64_tr_b16 v[40:41], v2 offset:12288
  v_mfma_f32_32x32x16_bf16 v[80:95], v[36:39], v[48:51], v[80:95]
  ds_read_b64_tr_b16 v[42:43], v2 offset:12800
  ds_read_b64_tr_b16 v[44:45], v3 offset:12288
  ds_read_b64_tr_b16 v[46:47], v3 offset:12800
  v_mfma_f32_32x32x16_bf16 v[96:111], v[32:35], v[52:55], v[96:111]
  v_add_u32 v9, s40, v9
  s_add_u32 s37, s37, 1
  s_cmp_eq_u32 s37, 3
  s_cselect_b32 s31, s41, s40
  s_cselect_b32 s37, 0, s37
  v_mfma_f32_32x32x16_bf16 v[112:127], v[36:39], v[52:55], v[112:127]
  v_add_u32 v2, s31, v2
  v_add_u32 v3, s31, v3
  s_waitcnt lgkmcnt(0)
  s_barrier
  v_mfma_f32_32x32x16_bf16 v[64:79], v[40:43], v[56:59], v[64:79]
  ds_read_b128 v[48:51], v6 offset:0
  ds_read_b128 v[52:55], v6 offset:4096
  ds_read_b64_tr_b16 v[32:33], v2 offset:0
  v_mfma_f32_32x32x16_bf16 v[80:95], v[44:47], v[56:59], v[80:95]
  ds_read_b64_tr_b16 v[34:35], v2 offset:512
  ds_read_b64_tr_b16 v[36:37], v3 offset:0
  ds_read_b64_tr_b16 v[38:39], v3 offset:512
  v_mfma_f32_32x32x16_bf16 v[96:111], v[40:43], v[60:63], v[96:111]
  v_add_u32 v6, s40, v6
  v_mfma_f32_32x32x16_bf16 v[112:127], v[44:47], v[60:63], v[112:127]
  s_getpc_b64 s[44:45]
  s_branch L_p1c_hook
  s_sub_u32 s36, s36, 1
  s_cmp_lg_u32 s36, 0
  s_cbranch_scc1 L_p1c_loopa
L_p1c_mid:
  s_waitcnt lgkmcnt(0)
  v_add_u32 v2, 16384, v4
  v_add_u32 v3, 16384, v5
  v_add_u32 v6, 4294836224, v6
  v_add_u32 v7, 4294852608, v7
  v_add_u32 v8, 4294852608, v8
  v_add_u32 v9, 4294852608, v9
  ds_read_b128 v[48:51], v6 offset:0
  ds_read_b128 v[52:55], v6 offset:4096
  ds_read_b64_tr_b16 v[32:33], v2 offset:0
  ds_read_b64_tr_b16 v[34:35], v2 offset:512
  ds_read_b64_tr_b16 v[36:37], v3 offset:0
  ds_read_b64_tr_b16 v[38:39], v3 offset:512
  v_add_u32 v6, s40, v6
  s_lshr_b32 s60, s2, 2
  s_and_b32 s61, s2, 3
  s_and_b32 s57, s61, 1
  s_mul_i32 s55, s30, 98304
  s_add_u32 s55, s55, 2097152
  s_add_u32 s48, s26, s55
  s_addc_u32 s49, s27, 0
  s_and_b32 s49, s49, 0xffff
  s_mov_b32 s50, 98304
  s_mov_b32 s51, 0x00020000
  v_lshlrev_b32 v248, 4, v1
  v_add_u32 v249, 4096, v248
  s_lshr_b32 s55, s61, 1
  s_mul_i32 s55, s55, 28
  s_mul_i32 s56, s57, 3
  s_add_u32 s55, s55, s56
  s_mul_i32 s56, s60, 56
  s_add_u32 s55, s55, s56
  s_lshl_b32 s55, s55, 9
  s_add_u32 s55, s55, 0
  s_xor_b32 s56, s30, 0
  s_mul_i32 s56, s56, 3584
  s_add_u32 s56, s56, s55
  v_add_u32 v250, s56, v248
  s_xor_b32 s56, s30, 1
  s_mul_i32 s56, s56, 3584
  s_add_u32 s56, s56, s55
  v_add_u32 v251, s56, v248
  s_xor_b32 s56, s30, 2
  s_mul_i32 s56, s56, 3584
  s_add_u32 s56, s56, s55
  v_add_u32 v252, s56, v248
  s_xor_b32 s56, s30, 3
  s_mul_i32 s56, s56, 3584
  s_add_u32 s56, s56, s55
  v_add_u32 v253, s56, v248
  s_lshl_b32 s55, s57, 11
  v_add_u32 v248, s55, v248
  s_cmp_eq_u32 s57, 0
  s_cselect_b32 s58, 0, -1
  s_cselect_b32 s59, -1, 0
  s_mov_b32 s54, 0
  s_mov_b32 s62, 0
  v_mov_b32 v254, 65536
  s_cmp_ge_u32 s30, 2
  s_cbranch_scc1 L_tc_skip
  s_mov_b32 s74, s20
  s_mov_b32 s75, s21
  s_movk_i32 s31, 49
  s_mov_b32 s32, 1605504
  s_cmp_eq_u32 s30, 1
  s_cselect_b32 s74, s12, s74
  s_cselect_b32 s75, s13, s75
  s_cselect_b32 s31, 13, s31
  s_cselect_b32 s32, 401280, s32
  s_sub_u32 s33, s31, 1
  v_min_u32 v17, s33, v1
  s_mul_i32 s31, s31, s2
  v_add_u32 v17, s31, v17
  v_lshlrev_b32 v17, 7, v17
  v_min_u32 v17, s32, v17
  global_load_dword v18, v17, s[74:75]
L_tc_skip:
  s_mov_b32 s36, 7
L_p1c_loopb:
  s_waitcnt lgkmcnt(0)
  v_mfma_f32_32x32x16_bf16 v[128:143], v[32:35], v[48:51], v[128:143]
  ds_read_b128 v[56:59], v7 offset:0
  ds_read_b128 v[60:63], v7 offset:4096
  ds_read_b64_tr_b16 v[40:41], v2 offset:4096
  v_mfma_f32_32x32x16_bf16 v[144:159], v[36:39], v[48:51], v[144:159]
  ds_read_b64_tr_b16 v[42:43], v2 offset:4608
  ds_read_b64_tr_b16 v[44:45], v3 offset:4096
  ds_read_b64_tr_b16 v[46:47], v3 offset:4608
  v_mfma_f32_32x32x16_bf16 v[160:175], v[32:35], v[52:55], v[160:175]
  v_add_u32 v7, s40, v7
  v_mfma_f32_32x32x16_bf16 v[176:191], v[36:39], v[52:55], v[176:191]
  s_waitcnt lgkmcnt(0)
  v_mfma_f32_32x32x16_bf16 v[128:143], v[40:43], v[56:59], v[128:143]
  ds_read_b128 v[48:51], v8 offset:0
  ds_read_b128 v[52:55], v8 offset:4096
  ds_read_b64_tr_b16 v[32:33], v2 offset:8192
  v_mfma_f32_32x32x16_bf16 v[144:159], v[44:47], v[56:59], v[144:159]
  ds_read_b64_tr_b16 v[34:35], v2 offset:8704
  ds_read_b64_tr_b16 v[36:37], v3 offset:8192
  ds_read_b64_tr_b16 v[38:39], v3 offset:8704
  v_mfma_f32_32x32x16_bf16 v[160:175], v[40:43], v[60:63], v[160:175]
  v_add_u32 v8, s40, v8
  v_mfma_f32_32x32x16_bf16 v[176:191], v[44:47], v[60:63], v[176:191]
  s_waitcnt lgkmcnt(0)
  v_mfma_f32_32x32x16_bf16 v[128:143], v[32:35], v[48:51], v[128:143]
  ds_read_b128 v[56:59], v9 offset:0
  ds_read_b128 v[60:63], v9 offset:4096
  ds_read_b64_tr_b16 v[40:41], v2 offset:12288
  v_mfma_f32_32x32x16_bf16 v[144:159], v[36:39], v[48:51], v[144:159]
  ds_read_b64_tr_b16 v[42:43], v2 offset:12800
  ds_read_b64_tr_b16 v[44:45], v3 offset:12288
  ds_read_b64_tr_b16 v[46:47], v3 offset:12800
  v_mfma_f32_32x32x16_bf16 v[160:175], v[32:35], v[52:55], v[160:175]
  v_add_u32 v9, s40, v9
  s_add_u32 s37, s37, 1
  s_cmp_eq_u32 s37, 3
  s_cselect_b32 s31, s41, s40
  s_cselect_b32 s37, 0, s37
  v_mfma_f32_32x32x16_bf16 v[176:191], v[36:39], v[52:55], v[176:191]
  v_add_u32 v2, s31, v2
  v_add_u32 v3, s31, v3
  s_waitcnt lgkmcnt(0)
  s_barrier
  v_mfma_f32_32x32x16_bf16 v[128:143], v[40:43], v[56:59], v[128:143]
  ds_read_b128 v[48:51], v6 offset:0
  ds_read_b128 v[52:55], v6 offset:4096
  ds_read_b64_tr_b16 v[32:33], v2 offset:0
  v_mfma_f32_32x32x16_bf16 v[144:159], v[44:47], v[56:59], v[144:159]
  ds_read_b64_tr_b16 v[34:35], v2 offset:512
  ds_read_b64_tr_b16 v[36:37], v3 offset:0
  ds_read_b64_tr_b16 v[38:39], v3 offset:512
  v_mfma_f32_32x32x16_bf16 v[160:175], v[40:43], v[60:63], v[160:175]
  v_add_u32 v6, s40, v6
  v_mfma_f32_32x32x16_bf16 v[176:191], v[44:47], v[60:63], v[176:191]
  s_cmp_eq_u32 s36, s46
  s_cbranch_scc1 L_p1c_epia
  s_cmp_eq_u32 s36, 5
  s_cbranch_scc1 L_p1c_bpoll
  s_cmp_eq_u32 s36, 3
  s_cbranch_scc1 L_p1c_bchk
  s_cmp_eq_u32 s36, 1
  s_cbranch_scc1 L_p1c_bepi
  s_cmp_eq_u32 s38, 0
  s_cbranch_scc1 L_p1c_back
  s_waitcnt vmcnt(0)
  v_lshl_add_u32 v17, v1, 8, s38
  v_mov_b32 v18, s35
  s_mov_b32 exec_lo, s42
  s_mov_b32 exec_hi, 0
  global_store_dword v17, v18, s[26:27] sc1
  s_mov_b64 exec, -1
  s_mov_b32 s38, 0
L_p1c_back:
  ds_read_b32 v255, v254
  s_sub_u32 s36, s36, 1
  s_cmp_lg_u32 s36, 0
  s_cbranch_scc1 L_p1c_loopb
  s_waitcnt lgkmcnt(0)
  v_readfirstlane_b32 s55, v255
  s_nop 1
  s_cmp_eq_u32 s55, 0
  s_cbranch_scc1 L_at_nopre
  global_load_dwordx4 v[64:67], v250, s[26:27] offset:0
  global_load_dwordx4 v[68:71], v250, s[26:27] offset:1024
  global_load_dwordx4 v[72:75], v251, s[26:27] offset:0
  global_load_dwordx4 v[76:79], v251, s[26:27] offset:1024
  global_load_dwordx4 v[80:83], v252, s[26:27] offset:0
  global_load_dwordx4 v[84:87], v252, s[26:27] offset:1024
  global_load_dwordx4 v[88:91], v253, s[26:27] offset:0
  global_load_dwordx4 v[92:95], v253, s[26:27] offset:1024
  s_mov_b32 s52, 0
  buffer_load_dwordx4 v[96:99], v248, s[48:51], s52 offen offset:0
  buffer_load_dwordx4 v[100:103], v248, s[48:51], s52 offen offset:1024
  buffer_load_dwordx4 v[104:107], v249, s[48:51], s52 offen offset:0
  buffer_load_dwordx4 v[108:111], v249, s[48:51], s52 offen offset:1024
  s_add_u32 s52, s52, 6144
  buffer_load_dwordx4 v[112:115], v248, s[48:51], s52 offen offset:0
  buffer_load_dwordx4 v[116:119], v248, s[48:51], s52 offen offset:1024
  buffer_load_dwordx4 v[120:123], v249, s[48:51], s52 offen offset:0
  buffer_load_dwordx4 v[124:127], v249, s[48:51], s52 offen offset:1024
  s_add_u32 s52, s52, 6144
  s_mov_b32 s62, 1
L_at_nopre:
  s_add_u32 s32, s29, 12
  v_mfma_f32_32x32x16_bf16 v[128:143], v[200:203], v[208:211], v[128:143]
  v_mfma_f32_32x32x16_bf16 v[144:159], v[204:207], v[208:211], v[144:159]
  v_mfma_f32_32x32x16_bf16 v[160:175], v[200:203], v[212:215], v[160:175]
  v_mfma_f32_32x32x16_bf16 v[176:191], v[204:207], v[212:215], v[176:191]
  s_lshl_b32 s32, s32, 2
  s_and_b32 s31, s30, 2
  s_add_u32 s32, s32, s31
  s_mul_i32 s31, s39, 112
  s_add_u32 s31, s31, s32
  s_lshl_b32 s31, s31, 10
  s_add_u32 s31, s31, 4194304
  v_add_u32 v17, s31, v16
  v_add_u32 v18, 114688, v17
  s_nop 3
  v_max_f32 v128, 0, v128
  v_max_f32 v129, 0, v129
  v_max_f32 v130, 0, v130
  v_max_f32 v131, 0, v131
  v_max_f32 v132, 0, v132
  v_max_f32 v133, 0, v133
  v_max_f32 v134, 0, v134
  v_max_f32 v135, 0, v135
  v_mul_f32 v128, v128, v136
  v_mul_f32 v129, v129, v137
  v_mul_f32 v130, v130, v138
  v_mul_f32 v131, v131, v139
  v_mul_f32 v132, v132, v140
  v_mul_f32 v133, v133, v141
  v_mul_f32 v134, v134, v142
  v_mul_f32 v135, v135, v143
  v_cvt_pk_bf16_f32 v216, v128, v129
  v_cvt_pk_bf16_f32 v217, v130, v131
  v_cvt_pk_bf16_f32 v218, v132, v133
  v_cvt_pk_bf16_f32 v219, v134, v135
  global_store_dwordx4 v17, v[216:219], s[26:27] offset:0 sc1
  v_max_f32 v144, 0, v144
  v_max_f32 v145, 0, v145
  v_max_f32 v146, 0, v146
  v_max_f32 v147, 0, v147
  v_max_f32 v148, 0, v148
  v_max_f32 v149, 0, v149
  v_max_f32 v150, 0, v150
  v_max_f32 v151, 0, v151
  v_mul_f32 v144, v144, v152
  v_mul_f32 v145, v145, v153
  v_mul_f32 v146, v146, v154
  v_mul_f32 v147, v147, v155
  v_mul_f32 v148, v148, v156
  v_mul_f32 v149, v149, v157
  v_mul_f32 v150, v150, v158
  v_mul_f32 v151, v151, v159
  v_cvt_pk_bf16_f32 v220, v144, v145
  v_cvt_pk_bf16_f32 v221, v146, v147
  v_cvt_pk_bf16_f32 v222, v148, v149
  v_cvt_pk_bf16_f32 v223, v150, v151
  global_store_dwordx4 v17, v[220:223], s[26:27] offset:1024 sc1
  v_max_f32 v160, 0, v160
  v_max_f32 v161, 0, v161
  v_max_f32 v162, 0, v162
  v_max_f32 v163, 0, v163
  v_max_f32 v164, 0, v164
  v_max_f32 v165, 0, v165
  v_max_f32 v166, 0, v166
  v_max_f32 v167, 0, v167
  v_mul_f32 v160, v160, v168
  v_mul_f32 v161, v161, v169
  v_mul_f32 v162, v162, v170
  v_mul_f32 v163, v163, v171
  v_mul_f32 v164, v164, v172
  v_mul_f32 v165, v165, v173
  v_mul_f32 v166, v166, v174
  v_mul_f32 v167, v167, v175
  v_cvt_pk_bf16_f32 v224, v160, v161
  v_cvt_pk_bf16_f32 v225, v162, v163
  v_cvt_pk_bf16_f32 v226, v164, v165
  v_cvt_pk_bf16_f32 v227, v166, v167
  global_store_dwordx4 v18, v[224:227], s[26:27] offset:0 sc1
  v_max_f32 v176, 0, v176
  v_max_f32 v177, 0, v177
  v_max_f32 v178, 0, v178
  v_max_f32 v179, 0, v179
  v_max_f32 v180, 0, v180
  v_max_f32 v181, 0, v181
  v_max_f32 v182, 0, v182
  v_max_f32 v183, 0, v183
  v_mul_f32 v176, v176, v184
  v_mul_f32 v177, v177, v185
  v_mul_f32 v178, v178, v186
  v_mul_f32 v179, v179, v187
  v_mul_f32 v180, v180, v188
  v_mul_f32 v181, v181, v189
  v_mul_f32 v182, v182, v190
  v_mul_f32 v183, v183, v191
  v_cvt_pk_bf16_f32 v228, v176, v177
  v_cvt_pk_bf16_f32 v229, v178, v179
  v_cvt_pk_bf16_f32 v230, v180, v181
  v_cvt_pk_bf16_f32 v231, v182, v183
  global_store_dwordx4 v18, v[228:231], s[26:27] offset:1024 sc1
  s_branch L_p1c_done
L_p1c_hook:
  s_add_u32 s44, s44, 4
  s_addc_u32 s45, s45, 0
  s_cmp_lg_u32 s36, 6
  s_cbranch_scc1 L_p1c_h5
  ds_read_b32 v29, v28
  s_waitcnt vmcnt(0)
  s_mov_b32 s31, 0x00003f80
  s_mov_b32 s32, 0x3f800000
  v_dot2_f32_bf16 v212, v192, s31, 0
  v_dot2_f32_bf16 v213, v192, s32, 0
  v_dot2_f32_bf16 v214, v193, s31, 0
  v_dot2_f32_bf16 v215, v193, s32, 0
  v_dot2_f32_bf16 v216, v194, s31, 0
  v_dot2_f32_bf16 v217, v194, s32, 0
  v_dot2_f32_bf16 v218, v195, s31, 0
  v_dot2_f32_bf16 v219, v195, s32, 0
  v_dot2_f32_bf16 v212, v196, s31, v212
  v_dot2_f32_bf16 v213, v196, s32, v213
  v_dot2_f32_bf16 v214, v197, s31, v214
  v_dot2_f32_bf16 v215, v197, s32, v215
  v_dot2_f32_bf16 v216, v198, s31, v216
  v_dot2_f32_bf16 v217, v198, s32, v217
  v_dot2_f32_bf16 v218, v199, s31, v218
  v_dot2_f32_bf16 v219, v199, s32, v219
  v_dot2_f32_bf16 v212, v200, s31, v212
  v_dot2_f32_bf16 v213, v200, s32, v213
  v_dot2_f32_bf16 v214, v201, s31, v214
  v_dot2_f32_bf16 v215, v201, s32, v215
  v_dot2_f32_bf16 v216, v202, s31, v216
  v_dot2_f32_bf16 v217, v202, s32, v217
  v_dot2_f32_bf16 v218, v203, s31, v218
  v_dot2_f32_bf16 v219, v203, s32, v219
  v_dot2_f32_bf16 v212, v204, s31, v212
  v_dot2_f32_bf16 v213, v204, s32, v213
  v_dot2_f32_bf16 v214, v205, s31, v214
  v_dot2_f32_bf16 v215, v205, s32, v215
  v_dot2_f32_bf16 v216, v206, s31, v216
  v_dot2_f32_bf16 v217, v206, s32, v217
  v_dot2_f32_bf16 v218, v207, s31, v218
  v_dot2_f32_bf16 v219, v207, s32, v219
  s_nop 2
  v_add_f32_dpp v212, v212, v212 row_ror:8 row_mask:0xf bank_mask:0xf
  v_add_f32_dpp v213, v213, v213 row_ror:8 row_mask:0xf bank_mask:0xf
  v_add_f32_dpp v214, v214, v214 row_ror:8 row_mask:0xf bank_mask:0xf
  v_add_f32_dpp v215, v215, v215 row_ror:8 row_mask:0xf bank_mask:0xf
  v_add_f32_dpp v216, v216, v216 row_ror:8 row_mask:0xf bank_mask:0xf
  v_add_f32_dpp v217, v217, v217 row_ror:8 row_mask:0xf bank_mask:0xf
  v_add_f32_dpp v218, v218, v218 row_ror:8 row_mask:0xf bank_mask:0xf
  v_add_f32_dpp v219, v219, v219 row_ror:8 row_mask:0xf bank_mask:0xf
  v_cndmask_b32 v212, v212, v213, s[68:69]
  v_cndmask_b32 v213, v214, v215, s[68:69]
  v_cndmask_b32 v214, v216, v217, s[68:69]
  v_cndmask_b32 v215, v218, v219, s[68:69]
  v_mov_b32 v220, v212
  v_mov_b32 v221, v213
  v_mov_b32 v222, v214
  v_mov_b32 v223, v215
  s_nop 1
  v_permlane16_swap_b32 v212, v220
  v_permlane16_swap_b32 v213, v221
  v_permlane16_swap_b32 v214, v222
  v_permlane16_swap_b32 v215, v223
  s_nop 1
  v_add_f32 v212, v212, v220
  v_add_f32 v213, v213, v221
  v_add_f32 v214, v214, v222
  v_add_f32 v215, v215, v223
  v_cndmask_b32 v212, v212, v213, s[70:71]
  v_cndmask_b32 v213, v214, v215, s[70:71]
  v_mov_b32 v220, v212
  v_mov_b32 v221, v213
  s_nop 1
  v_permlane32_swap_b32 v212, v220
  v_permlane32_swap_b32 v213, v221
  s_nop 1
  v_add_f32 v212, v212, v220
  v_add_f32 v213, v213, v221
  v_cndmask_b32 v212, v212, v213, s[72:73]
  global_store_dword v208, v212, s[26:27] sc1
  s_waitcnt lgkmcnt(0)
  v_mov_b32 v241, v29
  v_readfirstlane_b32 s35, v29
  s_mov_b64 exec, 3
  global_store_dwordx2 v242, v[240:241], s[26:27] sc1
  s_mov_b64 exec, -1
  s_cmp_eq_u32 s66, 0
  s_cbranch_scc1 L_p1c_h3
  v_mov_b32 v213, v29
  v_add_u32 v208, 262144, v208
  global_store_dwordx2 v208, v[212:213], s[26:27] sc1
  s_setpc_b64 s[44:45]
L_p1c_h5:
  s_cmp_lg_u32 s36, 4
  s_cbranch_scc1 L_p1c_h4
  s_waitcnt vmcnt(0)
  s_mov_b64 exec, 1
  global_store_dword v244, v29, s[26:27] sc1
  s_mov_b64 exec, -1
  s_setpc_b64 s[44:45]
L_p1c_h4:
  s_cmp_lg_u32 s36, 2
  s_cbranch_scc1 L_p1c_h3
  s_cmp_ge_u32 s29, 4
  s_cbranch_scc1 L_p1c_h3
  v_add_u32 v30, 262144, v12
  v_add_u32 v31, 262144, v13
  global_load_dwordx2 v[24:25], v23, s[26:27] sc1
  global_load_dwordx2 v[26:27], v23, s[26:27] offset:256 sc1
  global_load_dwordx2 v[216:217], v30, s[26:27] offset:-4096 sc1
  global_load_dwordx2 v[218:219], v30, s[26:27] offset:-3072 sc1
  global_load_dwordx2 v[220:221], v30, s[26:27] offset:-2048 sc1
  global_load_dwordx2 v[222:223], v30, s[26:27] offset:-1024 sc1
  global_load_dwordx2 v[224:225], v30, s[26:27] offset:0 sc1
  global_load_dwordx2 v[226:227], v30, s[26:27] offset:1024 sc1
  global_load_dwordx2 v[228:229], v30, s[26:27] offset:2048 sc1
  global_load_dwordx2 v[230:231], v30, s[26:27] offset:3072 sc1
  global_load_dwordx2 v[232:233], v31, s[26:27] offset:-4096 sc1
  global_load_dwordx2 v[234:235], v31, s[26:27] offset:-3072 sc1
  global_load_dwordx2 v[236:237], v31, s[26:27] offset:-2048 sc1
  global_load_dwordx2 v[238:239], v31, s[26:27] offset:-1024 sc1
  global_load_dwordx2 v[240:241], v31, s[26:27] offset:0 sc1
  global_load_dwordx2 v[242:243], v31, s[26:27] offset:1024 sc1
  global_load_dwordx2 v[244:245], v31, s[26:27] offset:2048 sc1
  global_load_dwordx2 v[246:247], v31, s[26:27] offset:3072 sc1
L_p1c_h3:
  s_setpc_b64 s[44:45]
L_p1c_bpoll:
  global_load_dwordx2 v[24:25], v23, s[26:27] sc1
  global_load_dwordx2 v[26:27], v23, s[26:27] offset:256 sc1
  global_load_dword v15, v14, s[26:27] sc1
  s_branch L_p1c_back
L_p1c_bchk:
  s_mov_b32 s33, 200000
L_p1c_ckb:
  s_waitcnt vmcnt(0)
  v_xor_b32 v17, s35, v25
  v_xor_b32 v18, s35, v27
  v_or_b32 v17, v17, v18
  v_xor_b32 v18, s35, v15
  v_or_b32 v17, v17, v18
  v_cmp_ne_u32 vcc, 0, v17
  s_sub_u32 s33, s33, 1
  s_cmp_eq_u32 s33, 0
  s_cbranch_scc1 L_p1c_okb
  s_cbranch_vccz L_p1c_okb
  s_sleep 4
  global_load_dwordx2 v[24:25], v23, s[26:27] sc1
  global_load_dwordx2 v[26:27], v23, s[26:27] offset:256 sc1
  global_load_dword v15, v14, s[26:27] sc1
  s_branch L_p1c_ckb
L_p1c_okb:
  global_load_dwordx2 v[216:217], v12, s[26:27] offset:-4096
  global_load_dwordx2 v[218:219], v12, s[26:27] offset:-3072
  global_load_dwordx2 v[220:221], v12, s[26:27] offset:-2048
  global_load_dwordx2 v[222:223], v12, s[26:27] offset:-1024
  global_load_dwordx2 v[224:225], v12, s[26:27] offset:0
  global_load_dwordx2 v[226:227], v12, s[26:27] offset:1024
  global_load_dwordx2 v[228:229], v12, s[26:27] offset:2048
  global_load_dwordx2 v[230:231], v12, s[26:27] offset:3072
  global_load_dwordx2 v[232:233], v13, s[26:27] offset:-4096
  global_load_dwordx2 v[234:235], v13, s[26:27] offset:-3072
  global_load_dwordx2 v[236:237], v13, s[26:27] offset:-2048
  global_load_dwordx2 v[238:239], v13, s[26:27] offset:-1024
  global_load_dwordx2 v[240:241], v13, s[26:27] offset:0
  global_load_dwordx2 v[242:243], v13, s[26:27] offset:1024
  global_load_dwordx2 v[244:245], v13, s[26:27] offset:2048
  global_load_dwordx2 v[246:247], v13, s[26:27] offset:3072
  s_branch L_p1c_back
L_p1c_bepi:
  s_waitcnt vmcnt(0)
  v_add_f32 v31, v217, v219
  v_add_f32 v19, v221, v223
  v_add_f32 v31, v31, v225
  v_add_f32 v19, v19, v227
  v_add_f32 v31, v31, v229
  v_add_f32 v19, v19, v231
  v_add_f32 v31, v31, v233
  v_add_f32 v19, v19, v235
  v_add_f32 v31, v31, v237
  v_add_f32 v19, v19, v239
  v_add_f32 v31, v31, v241
  v_add_f32 v19, v19, v243
  v_add_f32 v31, v31, v245
  v_add_f32 v19, v19, v247
  v_add_f32 v31, v31, v19
  s_cmp_ge_u32 s29, 4
  s_cbranch_scc1 L_p1c_epia2
  v_and_b32 v201, 0xffff0000, v31
  v_sub_f32 v202, v31, v201
  v_and_b32 v203, 0xffff0000, v202
  v_sub_f32 v202, v202, v203
  v_lshrrev_b32 v200, 16, v201
  v_or_b32 v200, v200, v203
  v_lshrrev_b32 v201, 16, v202
  v_mov_b32 v204, 0
  v_mov_b32 v205, 0
  v_mov_b32 v202, 0
  v_mov_b32 v203, 0
  v_mov_b32 v206, 0
  v_mov_b32 v207, 0
  v_permlane32_swap_b32 v200, v204
  v_permlane32_swap_b32 v201, v205
  s_branch L_p1c_back
L_p1c_epia:
  s_mov_b32 s33, 200000
L_p1c_cka:
  s_waitcnt vmcnt(0)
  v_xor_b32 v17, s35, v217
  v_xor_b32 v18, s35, v219
  v_or_b32 v17, v17, v18
  v_xor_b32 v18, s35, v221
  v_or_b32 v17, v17, v18
  v_xor_b32 v18, s35, v223
  v_or_b32 v17, v17, v18
  v_xor_b32 v18, s35, v225
  v_or_b32 v17, v17, v18
  v_xor_b32 v18, s35, v227
  v_or_b32 v17, v17, v18
  v_xor_b32 v18, s35, v229
  v_or_b32 v17, v17, v18
  v_xor_b32 v18, s35, v231
  v_or_b32 v17, v17, v18
  v_xor_b32 v18, s35, v233
  v_or_b32 v17, v17, v18
  v_xor_b32 v18, s35, v235
  v_or_b32 v17, v17, v18
  v_xor_b32 v18, s35, v237
  v_or_b32 v17, v17, v18
  v_xor_b32 v18, s35, v239
  v_or_b32 v17, v17, v18
  v_xor_b32 v18, s35, v241
  v_or_b32 v17, v17, v18
  v_xor_b32 v18, s35, v243
  v_or_b32 v17, v17, v18
  v_xor_b32 v18, s35, v245
  v_or_b32 v17, v17, v18
  v_xor_b32 v18, s35, v247
  v_or_b32 v17, v17, v18
  v_xor_b32 v18, s35, v25
  v_or_b32 v17, v17, v18
  v_xor_b32 v18, s35, v27
  v_or_b32 v17, v17, v18
  v_cmp_ne_u32 vcc, 0, v17
  s_sub_u32 s33, s33, 1
  s_cmp_eq_u32 s33, 0
  s_cbranch_scc1 L_p1c_oka
  s_cbranch_vccz L_p1c_oka
  s_sleep 4
  global_load_dwordx2 v[24:25], v23, s[26:27] sc1
  global_load_dwordx2 v[26:27], v23, s[26:27] offset:256 sc1
  global_load_dwordx2 v[216:217], v30, s[26:27] offset:-4096 sc1
  global_load_dwordx2 v[218:219], v30, s[26:27] offset:-3072 sc1
  global_load_dwordx2 v[220:221], v30, s[26:27] offset:-2048 sc1
  global_load_dwordx2 v[222:223], v30, s[26:27] offset:-1024 sc1
  global_load_dwordx2 v[224:225], v30, s[26:27] offset:0 sc1
  global_load_dwordx2 v[226:227], v30, s[26:27] offset:1024 sc1
  global_load_dwordx2 v[228:229], v30, s[26:27] offset:2048 sc1
  global_load_dwordx2 v[230:231], v30, s[26:27] offset:3072 sc1
  global_load_dwordx2 v[232:233], v31, s[26:27] offset:-4096 sc1
  global_load_dwordx2 v[234:235], v31, s[26:27] offset:-3072 sc1
  global_load_dwordx2 v[236:237], v31, s[26:27] offset:-2048 sc1
  global_load_dwordx2 v[238:239], v31, s[26:27] offset:-1024 sc1
  global_load_dwordx2 v[240:241], v31, s[26:27] offset:0 sc1
  global_load_dwordx2 v[242:243], v31, s[26:27] offset:1024 sc1
  global_load_dwordx2 v[244:245], v31, s[26:27] offset:2048 sc1
  global_load_dwordx2 v[246:247], v31, s[26:27] offset:3072 sc1
  s_branch L_p1c_cka
L_p1c_oka:
L_p1c_epia2:
  v_add_f32 v30, v216, v218
  v_add_f32 v19, v220, v222
  v_add_f32 v30, v30, v224
  v_add_f32 v19, v19, v226
  v_add_f32 v30, v30, v228
  v_add_f32 v19, v19, v230
  v_add_f32 v30, v30, v232
  v_add_f32 v19, v19, v234
  v_add_f32 v30, v30, v236
  v_add_f32 v19, v19, v238
  v_add_f32 v30, v30, v240
  v_add_f32 v19, v19, v242
  v_add_f32 v30, v30, v244
  v_add_f32 v19, v19, v246
  v_add_f32 v30, v30, v19
  v_and_b32 v193, 0xffff0000, v30
  v_sub_f32 v194, v30, v193
  v_and_b32 v195, 0xffff0000, v194
  v_sub_f32 v194, v194, v195
  v_lshrrev_b32 v192, 16, v193
  v_or_b32 v192, v192, v195
  v_lshrrev_b32 v193, 16, v194
  v_mov_b32 v196, 0
  v_mov_b32 v197, 0
  v_mov_b32 v194, 0
  v_mov_b32 v195, 0
  v_mov_b32 v198, 0
  v_mov_b32 v199, 0
  v_permlane32_swap_b32 v192, v196
  v_permlane32_swap_b32 v193, v197
  v_and_b32 v201, 0xffff0000, v31
  v_sub_f32 v202, v31, v201
  v_and_b32 v203, 0xffff0000, v202
  v_sub_f32 v202, v202, v203
  v_lshrrev_b32 v200, 16, v201
  v_or_b32 v200, v200, v203
  v_lshrrev_b32 v201, 16, v202
  v_mov_b32 v204, 0
  v_mov_b32 v205, 0
  v_mov_b32 v202, 0
  v_mov_b32 v203, 0
  v_mov_b32 v206, 0
  v_mov_b32 v207, 0
  v_permlane32_swap_b32 v200, v204
  v_permlane32_swap_b32 v201, v205
  v_and_b32 v209, 0xffff, v24
  v_xor_b32 v209, 0x8000, v209
  v_lshl_or_b32 v208, v209, 16, v209
  v_mov_b32 v210, 0
  v_mov_b32 v211, 0
  v_and_b32 v10, 0xffff0000, v24
  v_rcp_f32 v10, v10
  v_and_b32 v213, 0xffff, v26
  v_xor_b32 v213, 0x8000, v213
  v_lshl_or_b32 v212, v213, 16, v213
  v_mov_b32 v214, 0
  v_mov_b32 v215, 0
  v_and_b32 v11, 0xffff0000, v26
  v_rcp_f32 v11, v11
  s_mov_b32 exec_lo, 0
  v_mov_b32 v208, 0
  v_mov_b32 v209, 0
  v_mov_b32 v212, 0
  v_mov_b32 v213, 0
  s_mov_b64 exec, -1
  s_cmp_lt_u32 s29, 4
  s_cbranch_scc1 L_p1c_epiq
  s_sub_u32 s32, s29, 4
  v_mfma_f32_32x32x16_bf16 v[64:79], v[192:195], v[208:211], v[64:79]
  v_mfma_f32_32x32x16_bf16 v[80:95], v[196:199], v[208:211], v[80:95]
  v_mfma_f32_32x32x16_bf16 v[96:111], v[192:195], v[212:215], v[96:111]
  v_mfma_f32_32x32x16_bf16 v[112:127], v[196:199], v[212:215], v[112:127]
  s_lshl_b32 s32, s32, 2
  s_and_b32 s31, s30, 2
  s_add_u32 s32, s32, s31
  s_mul_i32 s31, s39, 112
  s_add_u32 s31, s31, s32
  s_lshl_b32 s31, s31, 10
  s_add_u32 s31, s31, 4194304
  v_add_u32 v17, s31, v16
  v_add_u32 v18, 114688, v17
  s_nop 3
  v_max_f32 v64, 0, v64
  v_max_f32 v65, 0, v65
  v_max_f32 v66, 0, v66
  v_max_f32 v67, 0, v67
  v_max_f32 v68, 0, v68
  v_max_f32 v69, 0, v69
  v_max_f32 v70, 0, v70
  v_max_f32 v71, 0, v71
  v_mul_f32 v64, v64, v72
  v_mul_f32 v65, v65, v73
  v_mul_f32 v66, v66, v74
  v_mul_f32 v67, v67, v75
  v_mul_f32 v68, v68, v76
  v_mul_f32 v69, v69, v77
  v_mul_f32 v70, v70, v78
  v_mul_f32 v71, v71, v79
  v_cvt_pk_bf16_f32 v216, v64, v65
  v_cvt_pk_bf16_f32 v217, v66, v67
  v_cvt_pk_bf16_f32 v218, v68, v69
  v_cvt_pk_bf16_f32 v219, v70, v71
  global_store_dwordx4 v17, v[216:219], s[26:27] offset:0 sc1
  v_max_f32 v80, 0, v80
  v_max_f32 v81, 0, v81
  v_max_f32 v82, 0, v82
  v_max_f32 v83, 0, v83
  v_max_f32 v84, 0, v84
  v_max_f32 v85, 0, v85
  v_max_f32 v86, 0, v86
  v_max_f32 v87, 0, v87
  v_mul_f32 v80, v80, v88
  v_mul_f32 v81, v81, v89
  v_mul_f32 v82, v82, v90
  v_mul_f32 v83, v83, v91
  v_mul_f32 v84, v84, v92
  v_mul_f32 v85, v85, v93
  v_mul_f32 v86, v86, v94
  v_mul_f32 v87, v87, v95
  v_cvt_pk_bf16_f32 v220, v80, v81
  v_cvt_pk_bf16_f32 v221, v82, v83
  v_cvt_pk_bf16_f32 v222, v84, v85
  v_cvt_pk_bf16_f32 v223, v86, v87
  global_store_dwordx4 v17, v[220:223], s[26:27] offset:1024 sc1
  v_max_f32 v96, 0, v96
  v_max_f32 v97, 0, v97
  v_max_f32 v98, 0, v98
  v_max_f32 v99, 0, v99
  v_max_f32 v100, 0, v100
  v_max_f32 v101, 0, v101
  v_max_f32 v102, 0, v102
  v_max_f32 v103, 0, v103
  v_mul_f32 v96, v96, v104
  v_mul_f32 v97, v97, v105
  v_mul_f32 v98, v98, v106
  v_mul_f32 v99, v99, v107
  v_mul_f32 v100, v100, v108
  v_mul_f32 v101, v101, v109
  v_mul_f32 v102, v102, v110
  v_mul_f32 v103, v103, v111
  v_cvt_pk_bf16_f32 v224, v96, v97
  v_cvt_pk_bf16_f32 v225, v98, v99
  v_cvt_pk_bf16_f32 v226, v100, v101
  v_cvt_pk_bf16_f32 v227, v102, v103
  global_store_dwordx4 v18, v[224:227], s[26:27] offset:0 sc1
  v_max_f32 v112, 0, v112
  v_max_f32 v113, 0, v113
  v_max_f32 v114, 0, v114
  v_max_f32 v115, 0, v115
  v_max_f32 v116, 0, v116
  v_max_f32 v117, 0, v117
  v_max_f32 v118, 0, v118
  v_max_f32 v119, 0, v119
  v_mul_f32 v112, v112, v120
  v_mul_f32 v113, v113, v121
  v_mul_f32 v114, v114, v122
  v_mul_f32 v115, v115, v123
  v_mul_f32 v116, v116, v124
  v_mul_f32 v117, v117, v125
  v_mul_f32 v118, v118, v126
  v_mul_f32 v119, v119, v127
  v_cvt_pk_bf16_f32 v228, v112, v113
  v_cvt_pk_bf16_f32 v229, v114, v115
  v_cvt_pk_bf16_f32 v230, v116, v117
  v_cvt_pk_bf16_f32 v231, v118, v119
  global_store_dwordx4 v18, v[228:231], s[26:27] offset:1024 sc1
  s_branch L_p1c_back
L_p1c_epiq:
  s_cmp_lg_u32 s29, 3
  s_cbranch_scc1 L_p1c_epiq2
  s_cmp_ge_u32 s30, 2
  s_cbranch_scc1 L_p1c_epikv
L_p1c_epiq2:
  v_mfma_f32_32x32x16_bf16 v[64:79], v[192:195], v[208:211], v[64:79]
  v_mfma_f32_32x32x16_bf16 v[80:95], v[196:199], v[208:211], v[80:95]
  v_mfma_f32_32x32x16_bf16 v[96:111], v[192:195], v[212:215], v[96:111]
  v_mfma_f32_32x32x16_bf16 v[112:127], v[196:199], v[212:215], v[112:127]
  s_mul_i32 s31, s39, 28672
  s_lshl_b32 s32, s29, 13
  s_add_u32 s31, s31, s32
  s_and_b32 s32, s30, 2
  s_lshl_b32 s32, s32, 11
  s_add_u32 s31, s31, s32
  s_add_u32 s31, s31, 0
  v_add_u32 v17, s31, v22
  v_add_u32 v18, 28672, v17
  v_mul_f32 v24, 0x3e8b97f6, v10
  v_mul_f32 v25, 0x3e8b97f6, v11
  s_nop 1
  v_mul_f32 v64, v64, v24
  v_mul_f32 v65, v65, v24
  v_mul_f32 v66, v66, v24
  v_mul_f32 v67, v67, v24
  v_mul_f32 v68, v68, v24
  v_mul_f32 v69, v69, v24
  v_mul_f32 v70, v70, v24
  v_mul_f32 v71, v71, v24
  v_mul_f32 v72, v72, v24
  v_mul_f32 v73, v73, v24
  v_mul_f32 v74, v74, v24
  v_mul_f32 v75, v75, v24
  v_mul_f32 v76, v76, v24
  v_mul_f32 v77, v77, v24
  v_mul_f32 v78, v78, v24
  v_mul_f32 v79, v79, v24
  v_cvt_pk_bf16_f32 v216, v64, v65
  v_cvt_pk_bf16_f32 v217, v66, v67
  v_cvt_pk_bf16_f32 v218, v68, v69
  v_cvt_pk_bf16_f32 v219, v70, v71
  v_cvt_pk_bf16_f32 v220, v72, v73
  v_cvt_pk_bf16_f32 v221, v74, v75
  v_cvt_pk_bf16_f32 v222, v76, v77
  v_cvt_pk_bf16_f32 v223, v78, v79
  global_store_dwordx4 v17, v[216:219], s[26:27] offset:0 sc1
  global_store_dwordx4 v17, v[220:223], s[26:27] offset:512 sc1
  v_mul_f32 v80, v80, v24
  v_mul_f32 v81, v81, v24
  v_mul_f32 v82, v82, v24
  v_mul_f32 v83, v83, v24
  v_mul_f32 v84, v84, v24
  v_mul_f32 v85, v85, v24
  v_mul_f32 v86, v86, v24
  v_mul_f32 v87, v87, v24
  v_mul_f32 v88, v88, v24
  v_mul_f32 v89, v89, v24
  v_mul_f32 v90, v90, v24
  v_mul_f32 v91, v91, v24
  v_mul_f32 v92, v92, v24
  v_mul_f32 v93, v93, v24
  v_mul_f32 v94, v94, v24
  v_mul_f32 v95, v95, v24
  v_cvt_pk_bf16_f32 v224, v80, v81
  v_cvt_pk_bf16_f32 v225, v82, v83
  v_cvt_pk_bf16_f32 v226, v84, v85
  v_cvt_pk_bf16_f32 v227, v86, v87
  v_cvt_pk_bf16_f32 v228, v88, v89
  v_cvt_pk_bf16_f32 v229, v90, v91
  v_cvt_pk_bf16_f32 v230, v92, v93
  v_cvt_pk_bf16_f32 v231, v94, v95
  global_store_dwordx4 v17, v[224:227], s[26:27] offset:2048 sc1
  global_store_dwordx4 v17, v[228:231], s[26:27] offset:2560 sc1
  v_mul_f32 v96, v96, v25
  v_mul_f32 v97, v97, v25
  v_mul_f32 v98, v98, v25
  v_mul_f32 v99, v99, v25
  v_mul_f32 v100, v100, v25
  v_mul_f32 v101, v101, v25
  v_mul_f32 v102, v102, v25
  v_mul_f32 v103, v103, v25
  v_mul_f32 v104, v104, v25
  v_mul_f32 v105, v105, v25
  v_mul_f32 v106, v106, v25
  v_mul_f32 v107, v107, v25
  v_mul_f32 v108, v108, v25
  v_mul_f32 v109, v109, v25
  v_mul_f32 v110, v110, v25
  v_mul_f32 v111, v111, v25
  v_cvt_pk_bf16_f32 v232, v96, v97
  v_cvt_pk_bf16_f32 v233, v98, v99
  v_cvt_pk_bf16_f32 v234, v100, v101
  v_cvt_pk_bf16_f32 v235, v102, v103
  v_cvt_pk_bf16_f32 v236, v104, v105
  v_cvt_pk_bf16_f32 v237, v106, v107
  v_cvt_pk_bf16_f32 v238, v108, v109
  v_cvt_pk_bf16_f32 v239, v110, v111
  global_store_dwordx4 v18, v[232:235], s[26:27] offset:0 sc1
  global_store_dwordx4 v18, v[236:239], s[26:27] offset:512 sc1
  v_mul_f32 v112, v112, v25
  v_mul_f32 v113, v113, v25
  v_mul_f32 v114, v114, v25
  v_mul_f32 v115, v115, v25
  v_mul_f32 v116, v116, v25
  v_mul_f32 v117, v117, v25
  v_mul_f32 v118, v118, v25
  v_mul_f32 v119, v119, v25
  v_mul_f32 v120, v120, v25
  v_mul_f32 v121, v121, v25
  v_mul_f32 v122, v122, v25
  v_mul_f32 v123, v123, v25
  v_mul_f32 v124, v124, v25
  v_mul_f32 v125, v125, v25
  v_mul_f32 v126, v126, v25
  v_mul_f32 v127, v127, v25
  v_cvt_pk_bf16_f32 v240, v112, v113
  v_cvt_pk_bf16_f32 v241, v114, v115
  v_cvt_pk_bf16_f32 v242, v116, v117
  v_cvt_pk_bf16_f32 v243, v118, v119
  v_cvt_pk_bf16_f32 v244, v120, v121
  v_cvt_pk_bf16_f32 v245, v122, v123
  v_cvt_pk_bf16_f32 v246, v124, v125
  v_cvt_pk_bf16_f32 v247, v126, v127
  global_store_dwordx4 v18, v[240:243], s[26:27] offset:2048 sc1
  global_store_dwordx4 v18, v[244:247], s[26:27] offset:2560 sc1
  s_lshl_b32 s31, s39, 7
  s_lshl_b32 s32, s29, 3
  s_add_u32 s31, s31, s32
  s_and_b32 s32, s30, 2
  s_lshl_b32 s32, s32, 1
  s_add_u32 s31, s31, s32
  s_add_u32 s38, s31, 2719872
  s_mov_b32 s42, 1
  s_branch L_p1c_back
L_p1c_epikv:
  v_mfma_f32_32x32x16_bf16 v[64:79], v[192:195], v[208:211], v[64:79]
  v_mfma_f32_32x32x16_bf16 v[80:95], v[208:211], v[196:199], v[80:95]
  v_mfma_f32_32x32x16_bf16 v[96:111], v[192:195], v[212:215], v[96:111]
  v_mfma_f32_32x32x16_bf16 v[112:127], v[212:215], v[196:199], v[112:127]
  v_cmp_eq_u32 s[42:43], 1, v21
  v_lshlrev_b32 v30, 4, v21
  s_mul_i32 s31, s39, 6144
  s_add_u32 s31, s31, 2099200
  v_mov_b32 v24, 0x3f803f80
  v_mov_b32 v25, 0x00003f80
  v_mov_b32 v26, 0
  v_cmp_eq_u32 vcc, 28, v20
  v_cmp_le_u32 s[44:45], 28, v20
  s_nop 0
  v_cndmask_b32 v29, v26, v24, vcc
  v_add_u32 v17, s31, v22
  v_add_u32 v18, s31, v16
  v_mul_f32 v64, v64, v10
  v_mul_f32 v65, v65, v10
  v_mul_f32 v66, v66, v10
  v_mul_f32 v67, v67, v10
  v_mul_f32 v68, v68, v10
  v_mul_f32 v69, v69, v10
  v_mul_f32 v70, v70, v10
  v_mul_f32 v71, v71, v10
  v_mul_f32 v72, v72, v10
  v_mul_f32 v73, v73, v10
  v_mul_f32 v74, v74, v10
  v_mul_f32 v75, v75, v10
  v_mul_f32 v76, v76, v10
  v_mul_f32 v77, v77, v10
  v_mul_f32 v78, v78, v10
  v_mul_f32 v79, v79, v10
  v_cvt_pk_bf16_f32 v218, v64, v65
  v_cvt_pk_bf16_f32 v219, v66, v67
  v_cvt_pk_bf16_f32 v220, v68, v69
  v_cvt_pk_bf16_f32 v221, v70, v71
  v_cvt_pk_bf16_f32 v222, v72, v73
  v_cvt_pk_bf16_f32 v223, v74, v75
  v_cvt_pk_bf16_f32 v224, v76, v77
  v_cvt_pk_bf16_f32 v225, v78, v79
  v_cndmask_b32 v224, v224, v24, s[42:43]
  v_cndmask_b32 v225, v225, v25, s[42:43]
  v_mov_b32 v216, v224
  v_mov_b32 v217, v225
  v_mov_b32 v19, v224
  v_mov_b32 v27, v225
  global_store_dwordx4 v17, v[218:221], s[26:27] offset:-2048 sc1
  global_store_dwordx4 v17, v[222:225], s[26:27] offset:-1536 sc1
  v_permlane32_swap_b32 v19, v216
  v_permlane32_swap_b32 v27, v217
  s_nop 1
  v_cndmask_b32 v216, v216, v19, s[42:43]
  v_cndmask_b32 v217, v217, v27, s[42:43]
  global_store_dwordx4 v17, v[216:219], s[26:27] sc1
  global_store_dwordx4 v17, v[220:223], s[26:27] offset:512 sc1
  v_readlane_b32 s64, v10, 0
  v_readlane_b32 s65, v10, 1
  v_readlane_b32 s66, v10, 2
  v_readlane_b32 s67, v10, 3
  v_readlane_b32 s68, v10, 8
  v_readlane_b32 s69, v10, 9
  v_readlane_b32 s70, v10, 10
  v_readlane_b32 s71, v10, 11
  s_mov_b32 exec_hi, 0
  s_nop 0
  v_mul_f32 v80, s64, v80
  v_mul_f32 v81, s65, v81
  v_mul_f32 v82, s66, v82
  v_mul_f32 v83, s67, v83
  v_mul_f32 v84, s68, v84
  v_mul_f32 v85, s69, v85
  v_mul_f32 v86, s70, v86
  v_mul_f32 v87, s71, v87
  s_mov_b64 exec, -1
  v_readlane_b32 s64, v10, 16
  v_readlane_b32 s65, v10, 17
  v_readlane_b32 s66, v10, 18
  v_readlane_b32 s67, v10, 19
  v_readlane_b32 s68, v10, 24
  v_readlane_b32 s69, v10, 25
  v_readlane_b32 s70, v10, 26
  v_readlane_b32 s71, v10, 27
  s_mov_b32 exec_hi, 0
  s_nop 0
  v_mul_f32 v88, s64, v88
  v_mul_f32 v89, s65, v89
  v_mul_f32 v90, s66, v90
  v_mul_f32 v91, s67, v91
  v_mul_f32 v92, s68, v92
  v_mul_f32 v93, s69, v93
  v_mul_f32 v94, s70, v94
  v_mul_f32 v95, s71, v95
  s_mov_b64 exec, -1
  v_readlane_b32 s64, v10, 4
  v_readlane_b32 s65, v10, 5
  v_readlane_b32 s66, v10, 6
  v_readlane_b32 s67, v10, 7
  v_readlane_b32 s68, v10, 12
  v_readlane_b32 s69, v10, 13
  v_readlane_b32 s70, v10, 14
  v_readlane_b32 s71, v10, 15
  s_mov_b32 exec_lo, 0
  s_nop 0
  v_mul_f32 v80, s64, v80
  v_mul_f32 v81, s65, v81
  v_mul_f32 v82, s66, v82
  v_mul_f32 v83, s67, v83
  v_mul_f32 v84, s68, v84
  v_mul_f32 v85, s69, v85
  v_mul_f32 v86, s70, v86
  v_mul_f32 v87, s71, v87
  s_mov_b64 exec, -1
  v_readlane_b32 s64, v10, 20
  v_readlane_b32 s65, v10, 21
  v_readlane_b32 s66, v10, 22
  v_readlane_b32 s67, v10, 23
  v_readlane_b32 s68, v10, 28
  v_readlane_b32 s69, v10, 29
  v_readlane_b32 s70, v10, 30
  v_readlane_b32 s71, v10, 31
  s_mov_b32 exec_lo, 0
  s_nop 0
  v_mul_f32 v88, s64, v88
  v_mul_f32 v89, s65, v89
  v_mul_f32 v90, s66, v90
  v_mul_f32 v91, s67, v91
  v_mul_f32 v92, s68, v92
  v_mul_f32 v93, s69, v93
  v_mul_f32 v94, s70, v94
  v_mul_f32 v95, s71, v95
  s_mov_b64 exec, -1
  v_cvt_pk_bf16_f32 v236, v80, v81
  v_cvt_pk_bf16_f32 v237, v82, v83
  v_cvt_pk_bf16_f32 v238, v84, v85
  v_cvt_pk_bf16_f32 v239, v86, v87
  v_cvt_pk_bf16_f32 v240, v88, v89
  v_cvt_pk_bf16_f32 v241, v90, v91
  v_cvt_pk_bf16_f32 v242, v92, v93
  v_cvt_pk_bf16_f32 v243, v94, v95
  v_cndmask_b32 v236, v236, v29, s[44:45]
  v_cndmask_b32 v237, v237, v29, s[44:45]
  v_cndmask_b32 v238, v238, v29, s[44:45]
  v_cndmask_b32 v239, v239, v29, s[44:45]
  v_cndmask_b32 v240, v240, v29, s[44:45]
  v_cndmask_b32 v241, v241, v29, s[44:45]
  v_cndmask_b32 v242, v242, v29, s[44:45]
  v_cndmask_b32 v243, v243, v29, s[44:45]
  global_store_dwordx4 v18, v[236:239], s[26:27] offset:2048 sc1
  global_store_dwordx4 v18, v[240:243], s[26:27] offset:3072 sc1
  s_add_u32 s31, s31, 6144
  v_add_u32 v17, s31, v22
  v_add_u32 v18, s31, v16
  v_mul_f32 v96, v96, v11
  v_mul_f32 v97, v97, v11
  v_mul_f32 v98, v98, v11
  v_mul_f32 v99, v99, v11
  v_mul_f32 v100, v100, v11
  v_mul_f32 v101, v101, v11
  v_mul_f32 v102, v102, v11
  v_mul_f32 v103, v103, v11
  v_mul_f32 v104, v104, v11
  v_mul_f32 v105, v105, v11
  v_mul_f32 v106, v106, v11
  v_mul_f32 v107, v107, v11
  v_mul_f32 v108, v108, v11
  v_mul_f32 v109, v109, v11
  v_mul_f32 v110, v110, v11
  v_mul_f32 v111, v111, v11
  v_cvt_pk_bf16_f32 v228, v96, v97
  v_cvt_pk_bf16_f32 v229, v98, v99
  v_cvt_pk_bf16_f32 v230, v100, v101
  v_cvt_pk_bf16_f32 v231, v102, v103
  v_cvt_pk_bf16_f32 v232, v104, v105
  v_cvt_pk_bf16_f32 v233, v106, v107
  v_cvt_pk_bf16_f32 v234, v108, v109
  v_cvt_pk_bf16_f32 v235, v110, v111
  v_cndmask_b32 v234, v234, v24, s[42:43]
  v_cndmask_b32 v235, v235, v25, s[42:43]
  v_mov_b32 v226, v234
  v_mov_b32 v227, v235
  v_mov_b32 v19, v234
  v_mov_b32 v27, v235
  global_store_dwordx4 v17, v[228:231], s[26:27] offset:-2048 sc1
  global_store_dwordx4 v17, v[232:235], s[26:27] offset:-1536 sc1
  v_permlane32_swap_b32 v19, v226
  v_permlane32_swap_b32 v27, v227
  s_nop 1
  v_cndmask_b32 v226, v226, v19, s[42:43]
  v_cndmask_b32 v227, v227, v27, s[42:43]
  global_store_dwordx4 v17, v[226:229], s[26:27] sc1
  global_store_dwordx4 v17, v[230:233], s[26:27] offset:512 sc1
  v_readlane_b32 s64, v11, 0
  v_readlane_b32 s65, v11, 1
  v_readlane_b32 s66, v11, 2
  v_readlane_b32 s67, v11, 3
  v_readlane_b32 s68, v11, 8
  v_readlane_b32 s69, v11, 9
  v_readlane_b32 s70, v11, 10
  v_readlane_b32 s71, v11, 11
  s_mov_b32 exec_hi, 0
  s_nop 0
  v_mul_f32 v112, s64, v112
  v_mul_f32 v113, s65, v113
  v_mul_f32 v114, s66, v114
  v_mul_f32 v115, s67, v115
  v_mul_f32 v116, s68, v116
  v_mul_f32 v117, s69, v117
  v_mul_f32 v118, s70, v118
  v_mul_f32 v119, s71, v119
  s_mov_b64 exec, -1
  v_readlane_b32 s64, v11, 16
  v_readlane_b32 s65, v11, 17
  v_readlane_b32 s66, v11, 18
  v_readlane_b32 s67, v11, 19
  v_readlane_b32 s68, v11, 24
  v_readlane_b32 s69, v11, 25
  v_readlane_b32 s70, v11, 26
  v_readlane_b32 s71, v11, 27
  s_mov_b32 exec_hi, 0
  s_nop 0
  v_mul_f32 v120, s64, v120
  v_mul_f32 v121, s65, v121
  v_mul_f32 v122, s66, v122
  v_mul_f32 v123, s67, v123
  v_mul_f32 v124, s68, v124
  v_mul_f32 v125, s69, v125
  v_mul_f32 v126, s70, v126
  v_mul_f32 v127, s71, v127
  s_mov_b64 exec, -1
  v_readlane_b32 s64, v11, 4
  v_readlane_b32 s65, v11, 5
  v_readlane_b32 s66, v11, 6
  v_readlane_b32 s67, v11, 7
  v_readlane_b32 s68, v11, 12
  v_readlane_b32 s69, v11, 13
  v_readlane_b32 s70, v11, 14
  v_readlane_b32 s71, v11, 15
  s_mov_b32 exec_lo, 0
  s_nop 0
  v_mul_f32 v112, s64, v112
  v_mul_f32 v113, s65, v113
  v_mul_f32 v114, s66, v114
  v_mul_f32 v115, s67, v115
  v_mul_f32 v116, s68, v116
  v_mul_f32 v117, s69, v117
  v_mul_f32 v118, s70, v118
  v_mul_f32 v119, s71, v119
  s_mov_b64 exec, -1
  v_readlane_b32 s64, v11, 20
  v_readlane_b32 s65, v11, 21
  v_readlane_b32 s66, v11, 22
  v_readlane_b32 s67, v11, 23
  v_readlane_b32 s68, v11, 28
  v_readlane_b32 s69, v11, 29
  v_readlane_b32 s70, v11, 30
  v_readlane_b32 s71, v11, 31
  s_mov_b32 exec_lo, 0
  s_nop 0
  v_mul_f32 v120, s64, v120
  v_mul_f32 v121, s65, v121
  v_mul_f32 v122, s66, v122
  v_mul_f32 v123, s67, v123
  v_mul_f32 v124, s68, v124
  v_mul_f32 v125, s69, v125
  v_mul_f32 v126, s70, v126
  v_mul_f32 v127, s71, v127
  s_mov_b64 exec, -1
  v_cvt_pk_bf16_f32 v236, v112, v113
  v_cvt_pk_bf16_f32 v237, v114, v115
  v_cvt_pk_bf16_f32 v238, v116, v117
  v_cvt_pk_bf16_f32 v239, v118, v119
  v_cvt_pk_bf16_f32 v240, v120, v121
  v_cvt_pk_bf16_f32 v241, v122, v123
  v_cvt_pk_bf16_f32 v242, v124, v125
  v_cvt_pk_bf16_f32 v243, v126, v127
  v_cndmask_b32 v236, v236, v29, s[44:45]
  v_cndmask_b32 v237, v237, v29, s[44:45]
  v_cndmask_b32 v238, v238, v29, s[44:45]
  v_cndmask_b32 v239, v239, v29, s[44:45]
  v_cndmask_b32 v240, v240, v29, s[44:45]
  v_cndmask_b32 v241, v241, v29, s[44:45]
  v_cndmask_b32 v242, v242, v29, s[44:45]
  v_cndmask_b32 v243, v243, v29, s[44:45]
  global_store_dwordx4 v18, v[236:239], s[26:27] offset:2048 sc1
  global_store_dwordx4 v18, v[240:243], s[26:27] offset:3072 sc1
  s_add_u32 s31, s31, 6144
  s_lshl_b32 s31, s39, 1
  s_add_u32 s38, s31, 2719744
  s_mov_b32 s42, -1
  s_branch L_p1c_back
L_p1c_done:
  s_lshl_b32 s31, s39, 6
  s_lshl_b32 s32, s29, 3
  s_add_u32 s31, s31, s32
  s_and_b32 s32, s30, 2
  s_lshl_b32 s32, s32, 1
  s_add_u32 s31, s31, s32
  s_add_u32 s31, s31, 2689024
  s_mov_b32 s36, s31
  s_setprio 2
  s_cmp_lg_u32 s62, 0
  s_cbranch_scc1 L_at_havepre
  v_mov_b32 v4, 65536
  s_mov_b32 s53, 3200000
L_rwkv:
  ds_read_b32 v5, v4
  s_waitcnt lgkmcnt(0)
  v_readfirstlane_b32 s55, v5
  s_sub_u32 s53, s53, 1
  s_cmp_eq_u32 s53, 0
  s_cbranch_scc1 L_rwdkv
  s_cmp_lg_u32 s55, 0
  s_cbranch_scc1 L_rwdkv
  s_sleep 1
  s_branch L_rwkv
L_rwdkv:
  global_load_dwordx4 v[64:67], v250, s[26:27] offset:0
  global_load_dwordx4 v[68:71], v250, s[26:27] offset:1024
  global_load_dwordx4 v[72:75], v251, s[26:27] offset:0
  global_load_dwordx4 v[76:79], v251, s[26:27] offset:1024
  global_load_dwordx4 v[80:83], v252, s[26:27] offset:0
  global_load_dwordx4 v[84:87], v252, s[26:27] offset:1024
  global_load_dwordx4 v[88:91], v253, s[26:27] offset:0
  global_load_dwordx4 v[92:95], v253, s[26:27] offset:1024
  s_mov_b32 s52, 0
  buffer_load_dwordx4 v[96:99], v248, s[48:51], s52 offen offset:0
  buffer_load_dwordx4 v[100:103], v248, s[48:51], s52 offen offset:1024
  buffer_load_dwordx4 v[104:107], v249, s[48:51], s52 offen offset:0
  buffer_load_dwordx4 v[108:111], v249, s[48:51], s52 offen offset:1024
  s_add_u32 s52, s52, 6144
  buffer_load_dwordx4 v[112:115], v248, s[48:51], s52 offen offset:0
  buffer_load_dwordx4 v[116:119], v248, s[48:51], s52 offen offset:1024
  buffer_load_dwordx4 v[120:123], v249, s[48:51], s52 offen offset:0
  buffer_load_dwordx4 v[124:127], v249, s[48:51], s52 offen offset:1024
  s_add_u32 s52, s52, 6144
  s_mov_b32 s62, 1
  s_waitcnt vmcnt(0)
L_at_havepre:
  buffer_load_dwordx4 v[128:131], v248, s[48:51], s52 offen offset:0
  buffer_load_dwordx4 v[132:135], v248, s[48:51], s52 offen offset:1024
  buffer_load_dwordx4 v[136:139], v249, s[48:51], s52 offen offset:0
  buffer_load_dwordx4 v[140:143], v249, s[48:51], s52 offen offset:1024
  s_add_u32 s52, s52, 6144
  s_waitcnt vmcnt(14)
  s_mov_b64 exec, s[58:59]
  s_cmp_eq_u32 s57, 0
  s_cbranch_scc0 L_at_padodd0
  v_mov_b32 v70, 0
  v_mov_b32 v71, 0
  v_mov_b32 v78, 0
  v_mov_b32 v79, 0
  v_mov_b32 v86, 0
  v_mov_b32 v87, 0
  v_mov_b32 v94, 0
  v_mov_b32 v95, 0
  s_branch L_at_paddone0
L_at_padodd0:
  v_mov_b32 v64, 0
  v_mov_b32 v65, 0
  v_mov_b32 v72, 0
  v_mov_b32 v73, 0
  v_mov_b32 v80, 0
  v_mov_b32 v81, 0
  v_mov_b32 v88, 0
  v_mov_b32 v89, 0
L_at_paddone0:
  s_mov_b64 exec, -1
  s_nop 1
  v_mfma_f32_32x32x16_bf16 v[160:175], v[96:99], v[64:67], 0
  v_mfma_f32_32x32x16_bf16 v[160:175], v[100:103], v[68:71], v[160:175]
  v_mfma_f32_32x32x16_bf16 v[176:191], v[96:99], v[72:75], 0
  v_mfma_f32_32x32x16_bf16 v[176:191], v[100:103], v[76:79], v[176:191]
  v_mfma_f32_32x32x16_bf16 v[192:207], v[96:99], v[80:83], 0
  v_mfma_f32_32x32x16_bf16 v[192:207], v[100:103], v[84:87], v[192:207]
  v_mfma_f32_32x32x16_bf16 v[208:223], v[96:99], v[88:91], 0
  v_mfma_f32_32x32x16_bf16 v[208:223], v[100:103], v[92:95], v[208:223]
  s_nop 5
  v_max3_f32 v12, v160, v161, v162
  v_max3_f32 v12, v12, v163, v164
  v_max3_f32 v12, v12, v165, v166
  v_max3_f32 v12, v12, v167, v168
  v_max3_f32 v12, v12, v169, v170
  v_max3_f32 v12, v12, v171, v172
  v_max3_f32 v12, v12, v173, v174
  v_max_f32 v12, v12, v175
  v_max3_f32 v13, v176, v177, v178
  v_max3_f32 v13, v13, v179, v180
  v_max3_f32 v13, v13, v181, v182
  v_max3_f32 v13, v13, v183, v184
  v_max3_f32 v13, v13, v185, v186
  v_max3_f32 v13, v13, v187, v188
  v_max3_f32 v13, v13, v189, v190
  v_max_f32 v13, v13, v191
  v_max3_f32 v14, v192, v193, v194
  v_max3_f32 v14, v14, v195, v196
  v_max3_f32 v14, v14, v197, v198
  v_max3_f32 v14, v14, v199, v200
  v_max3_f32 v14, v14, v201, v202
  v_max3_f32 v14, v14, v203, v204
  v_max3_f32 v14, v14, v205, v206
  v_max_f32 v14, v14, v207
  v_max3_f32 v15, v208, v209, v210
  v_max3_f32 v15, v15, v211, v212
  v_max3_f32 v15, v15, v213, v214
  v_max3_f32 v15, v15, v215, v216
  v_max3_f32 v15, v15, v217, v218
  v_max3_f32 v15, v15, v219, v220
  v_max3_f32 v15, v15, v221, v222
  v_max_f32 v15, v15, v223
L_at_setmax:
  v_mov_b32 v4, v12
  v_mov_b32 v5, v13
  v_mov_b32 v6, v14
  v_mov_b32 v7, v15
  s_nop 1
  v_permlane32_swap_b32 v12, v4
  v_permlane32_swap_b32 v13, v5
  v_permlane32_swap_b32 v14, v6
  v_permlane32_swap_b32 v15, v7
  s_nop 1
  v_max_f32 v12, v12, v4
  v_max_f32 v13, v13, v5
  v_max_f32 v14, v14, v6
  v_max_f32 v15, v15, v7
  v_and_b32 v16, 0xffff0000, v12
  v_sub_f32 v17, v12, v16
  v_and_b32 v18, 0xffff0000, v17
  v_sub_f32 v17, v17, v18
  v_lshrrev_b32 v16, 16, v16
  v_or_b32 v16, v16, v18
  v_xor_b32 v16, 0x80008000, v16
  v_lshrrev_b32 v17, 16, v17
  v_xor_b32 v17, 0x8000, v17
  v_and_b32 v20, 0xffff0000, v13
  v_sub_f32 v21, v13, v20
  v_and_b32 v22, 0xffff0000, v21
  v_sub_f32 v21, v21, v22
  v_lshrrev_b32 v20, 16, v20
  v_or_b32 v20, v20, v22
  v_xor_b32 v20, 0x80008000, v20
  v_lshrrev_b32 v21, 16, v21
  v_xor_b32 v21, 0x8000, v21
  v_and_b32 v24, 0xffff0000, v14
  v_sub_f32 v25, v14, v24
  v_and_b32 v26, 0xffff0000, v25
  v_sub_f32 v25, v25, v26
  v_lshrrev_b32 v24, 16, v24
  v_or_b32 v24, v24, v26
  v_xor_b32 v24, 0x80008000, v24
  v_lshrrev_b32 v25, 16, v25
  v_xor_b32 v25, 0x8000, v25
  v_and_b32 v28, 0xffff0000, v15
  v_sub_f32 v29, v15, v28
  v_and_b32 v30, 0xffff0000, v29
  v_sub_f32 v29, v29, v30
  v_lshrrev_b32 v28, 16, v28
  v_or_b32 v28, v28, v30
  v_xor_b32 v28, 0x80008000, v28
  v_lshrrev_b32 v29, 16, v29
  v_xor_b32 v29, 0x8000, v29
  s_mov_b64 exec, s[58:59]
  s_cmp_eq_u32 s57, 0
  s_cbranch_scc0 L_at_padodd1
  v_mov_b32 v70, v16
  v_mov_b32 v71, v17
  v_mov_b32 v78, v20
  v_mov_b32 v79, v21
  v_mov_b32 v86, v24
  v_mov_b32 v87, v25
  v_mov_b32 v94, v28
  v_mov_b32 v95, v29
  s_branch L_at_paddone1
L_at_padodd1:
  v_mov_b32 v64, v16
  v_mov_b32 v65, v17
  v_mov_b32 v72, v20
  v_mov_b32 v73, v21
  v_mov_b32 v80, v24
  v_mov_b32 v81, v25
  v_mov_b32 v88, v28
  v_mov_b32 v89, v29
L_at_paddone1:
  s_mov_b64 exec, -1
  s_nop 0
  v_mfma_f32_32x32x16_bf16 v[16:31], v[96:99], v[64:67], 0
  v_mfma_f32_32x32x16_bf16 v[16:31], v[100:103], v[68:71], v[16:31]
  v_mov_b32 v160, 0
  v_mov_b32 v161, 0
  v_mov_b32 v162, 0
  v_mov_b32 v163, 0
  v_mov_b32 v164, 0
  v_mov_b32 v165, 0
  v_mov_b32 v166, 0
  v_mov_b32 v167, 0
  v_mov_b32 v168, 0
  v_mov_b32 v169, 0
  v_mov_b32 v170, 0
  v_mov_b32 v171, 0
  v_mov_b32 v172, 0
  v_mov_b32 v173, 0
  v_mov_b32 v174, 0
  v_mov_b32 v175, 0
  v_mov_b32 v176, 0
  v_mov_b32 v177, 0
  v_mov_b32 v178, 0
  v_mov_b32 v179, 0
  v_mov_b32 v180, 0
  v_mov_b32 v181, 0
  v_mov_b32 v182, 0
  v_mov_b32 v183, 0
  v_mov_b32 v184, 0
  v_mov_b32 v185, 0
  v_mov_b32 v186, 0
  v_mov_b32 v187, 0
  v_mov_b32 v188, 0
  v_mov_b32 v189, 0
  v_mov_b32 v190, 0
  v_mov_b32 v191, 0
  v_mov_b32 v192, 0
  v_mov_b32 v193, 0
  v_mov_b32 v194, 0
  v_mov_b32 v195, 0
  v_mov_b32 v196, 0
  v_mov_b32 v197, 0
  v_mov_b32 v198, 0
  v_mov_b32 v199, 0
  v_mov_b32 v200, 0
  v_mov_b32 v201, 0
  v_mov_b32 v202, 0
  v_mov_b32 v203, 0
  v_mov_b32 v204, 0
  v_mov_b32 v205, 0
  v_mov_b32 v206, 0
  v_mov_b32 v207, 0
  v_mov_b32 v208, 0
  v_mov_b32 v209, 0
  v_mov_b32 v210, 0
  v_mov_b32 v211, 0
  v_mov_b32 v212, 0
  v_mov_b32 v213, 0
  v_mov_b32 v214, 0
  v_mov_b32 v215, 0
  v_mov_b32 v216, 0
  v_mov_b32 v217, 0
  v_mov_b32 v218, 0
  v_mov_b32 v219, 0
  v_mov_b32 v220, 0
  v_mov_b32 v221, 0
  v_mov_b32 v222, 0
  v_mov_b32 v223, 0
  v_mov_b32 v56, 0
  v_mov_b32 v152, 0
  v_mov_b32 v57, 0
  v_mov_b32 v153, 0
  v_mov_b32 v58, 0
  v_mov_b32 v154, 0
  v_mov_b32 v59, 0
  v_mov_b32 v155, 0
  v_mov_b32 v60, 0
  v_mov_b32 v156, 0
  v_mov_b32 v61, 0
  v_mov_b32 v157, 0
  v_mov_b32 v62, 0
  v_mov_b32 v158, 0
  v_mov_b32 v63, 0
  v_mov_b32 v159, 0
  s_cmp_lg_u32 s54, 0
  s_cbranch_scc1 L_at_noh
  s_waitcnt vmcnt(4)
  v_mov_b32 v4, s36
  v_mov_b32 v5, s35
  s_mov_b64 exec, 1
  global_store_dword v4, v5, s[26:27] sc1
  s_mov_b64 exec, -1
L_at_noh:
  s_mov_b32 s53, 4
L_at_main:
  v_mfma_f32_32x32x16_bf16 v[32:47], v[96:99], v[72:75], 0
  v_exp_f32 v16, v16
  v_exp_f32 v17, v17
  v_exp_f32 v18, v18
  v_exp_f32 v19, v19
  v_mfma_f32_32x32x16_bf16 v[32:47], v[100:103], v[76:79], v[32:47]
  v_exp_f32 v20, v20
  v_exp_f32 v21, v21
  v_exp_f32 v22, v22
  v_exp_f32 v23, v23
  v_cvt_pk_bf16_f32 v48, v16, v17
  v_cvt_pk_bf16_f32 v49, v18, v19
  v_mfma_f32_32x32x16_bf16 v[208:223], v[152:155], v[56:59], v[208:223]
  v_exp_f32 v24, v24
  v_exp_f32 v25, v25
  v_exp_f32 v26, v26
  v_exp_f32 v27, v27
  v_cvt_pk_bf16_f32 v50, v20, v21
  v_cvt_pk_bf16_f32 v51, v22, v23
  v_mfma_f32_32x32x16_bf16 v[208:223], v[156:159], v[60:63], v[208:223]
  v_exp_f32 v28, v28
  v_exp_f32 v29, v29
  v_exp_f32 v30, v30
  v_exp_f32 v31, v31
  v_cvt_pk_bf16_f32 v52, v24, v25
  v_cvt_pk_bf16_f32 v53, v26, v27
  v_cvt_pk_bf16_f32 v54, v28, v29
  v_cvt_pk_bf16_f32 v55, v30, v31
  s_waitcnt vmcnt(8)
  v_mfma_f32_32x32x16_bf16 v[16:31], v[96:99], v[80:83], 0
  v_exp_f32 v32, v32
  v_exp_f32 v33, v33
  v_exp_f32 v34, v34
  v_exp_f32 v35, v35
  v_mfma_f32_32x32x16_bf16 v[16:31], v[100:103], v[84:87], v[16:31]
  v_exp_f32 v36, v36
  v_exp_f32 v37, v37
  v_exp_f32 v38, v38
  v_exp_f32 v39, v39
  v_cvt_pk_bf16_f32 v56, v32, v33
  v_cvt_pk_bf16_f32 v57, v34, v35
  v_mfma_f32_32x32x16_bf16 v[160:175], v[104:107], v[48:51], v[160:175]
  v_exp_f32 v40, v40
  v_exp_f32 v41, v41
  v_exp_f32 v42, v42
  v_exp_f32 v43, v43
  v_cvt_pk_bf16_f32 v58, v36, v37
  v_cvt_pk_bf16_f32 v59, v38, v39
  v_mfma_f32_32x32x16_bf16 v[160:175], v[108:111], v[52:55], v[160:175]
  v_exp_f32 v44, v44
  v_exp_f32 v45, v45
  v_exp_f32 v46, v46
  v_exp_f32 v47, v47
  v_cvt_pk_bf16_f32 v60, v40, v41
  v_cvt_pk_bf16_f32 v61, v42, v43
  v_cvt_pk_bf16_f32 v62, v44, v45
  v_cvt_pk_bf16_f32 v63, v46, v47
  buffer_load_dwordx4 v[144:147], v248, s[48:51], s52 offen offset:0
  buffer_load_dwordx4 v[148:151], v248, s[48:51], s52 offen offset:1024
  buffer_load_dwordx4 v[152:155], v249, s[48:51], s52 offen offset:0
  buffer_load_dwordx4 v[156:159], v249, s[48:51], s52 offen offset:1024
  s_add_u32 s52, s52, 6144
  v_mfma_f32_32x32x16_bf16 v[32:47], v[96:99], v[88:91], 0
  v_exp_f32 v16, v16
  v_exp_f32 v17, v17
  v_exp_f32 v18, v18
  v_exp_f32 v19, v19
  v_mfma_f32_32x32x16_bf16 v[32:47], v[100:103], v[92:95], v[32:47]
  v_exp_f32 v20, v20
  v_exp_f32 v21, v21
  v_exp_f32 v22, v22
  v_exp_f32 v23, v23
  v_cvt_pk_bf16_f32 v48, v16, v17
  v_cvt_pk_bf16_f32 v49, v18, v19
  v_mfma_f32_32x32x16_bf16 v[176:191], v[104:107], v[56:59], v[176:191]
  v_exp_f32 v24, v24
  v_exp_f32 v25, v25
  v_exp_f32 v26, v26
  v_exp_f32 v27, v27
  v_cvt_pk_bf16_f32 v50, v20, v21
  v_cvt_pk_bf16_f32 v51, v22, v23
  v_mfma_f32_32x32x16_bf16 v[176:191], v[108:111], v[60:63], v[176:191]
  v_exp_f32 v28, v28
  v_exp_f32 v29, v29
  v_exp_f32 v30, v30
  v_exp_f32 v31, v31
  v_cvt_pk_bf16_f32 v52, v24, v25
  v_cvt_pk_bf16_f32 v53, v26, v27
  v_cvt_pk_bf16_f32 v54, v28, v29
  v_cvt_pk_bf16_f32 v55, v30, v31
  s_waitcnt vmcnt(10)
  v_mfma_f32_32x32x16_bf16 v[16:31], v[112:115], v[64:67], 0
  v_exp_f32 v32, v32
  v_exp_f32 v33, v33
  v_exp_f32 v34, v34
  v_exp_f32 v35, v35
  v_mfma_f32_32x32x16_bf16 v[16:31], v[116:119], v[68:71], v[16:31]
  v_exp_f32 v36, v36
  v_exp_f32 v37, v37
  v_exp_f32 v38, v38
  v_exp_f32 v39, v39
  v_cvt_pk_bf16_f32 v56, v32, v33
  v_cvt_pk_bf16_f32 v57, v34, v35
  v_mfma_f32_32x32x16_bf16 v[192:207], v[104:107], v[48:51], v[192:207]
  v_exp_f32 v40, v40
  v_exp_f32 v41, v41
  v_exp_f32 v42, v42
  v_exp_f32 v43, v43
  v_cvt_pk_bf16_f32 v58, v36, v37
  v_cvt_pk_bf16_f32 v59, v38, v39
  v_mfma_f32_32x32x16_bf16 v[192:207], v[108:111], v[52:55], v[192:207]
  v_exp_f32 v44, v44
  v_exp_f32 v45, v45
  v_exp_f32 v46, v46
  v_exp_f32 v47, v47
  v_cvt_pk_bf16_f32 v60, v40, v41
  v_cvt_pk_bf16_f32 v61, v42, v43
  v_cvt_pk_bf16_f32 v62, v44, v45
  v_cvt_pk_bf16_f32 v63, v46, v47
  v_mfma_f32_32x32x16_bf16 v[32:47], v[112:115], v[72:75], 0
  v_exp_f32 v16, v16
  v_exp_f32 v17, v17
  v_exp_f32 v18, v18
  v_exp_f32 v19, v19
  v_mfma_f32_32x32x16_bf16 v[32:47], v[116:119], v[76:79], v[32:47]
  v_exp_f32 v20, v20
  v_exp_f32 v21, v21
  v_exp_f32 v22, v22
  v_exp_f32 v23, v23
  v_cvt_pk_bf16_f32 v48, v16, v17
  v_cvt_pk_bf16_f32 v49, v18, v19
  v_mfma_f32_32x32x16_bf16 v[208:223], v[104:107], v[56:59], v[208:223]
  v_exp_f32 v24, v24
  v_exp_f32 v25, v25
  v_exp_f32 v26, v26
  v_exp_f32 v27, v27
  v_cvt_pk_bf16_f32 v50, v20, v21
  v_cvt_pk_bf16_f32 v51, v22, v23
  v_mfma_f32_32x32x16_bf16 v[208:223], v[108:111], v[60:63], v[208:223]
  v_exp_f32 v28, v28
  v_exp_f32 v29, v29
  v_exp_f32 v30, v30
  v_exp_f32 v31, v31
  v_cvt_pk_bf16_f32 v52, v24, v25
  v_cvt_pk_bf16_f32 v53, v26, v27
  v_cvt_pk_bf16_f32 v54, v28, v29
  v_cvt_pk_bf16_f32 v55, v30, v31
  s_waitcnt vmcnt(8)
  v_mfma_f32_32x32x16_bf16 v[16:31], v[112:115], v[80:83], 0
  v_exp_f32 v32, v32
  v_exp_f32 v33, v33
  v_exp_f32 v34, v34
  v_exp_f32 v35, v35
  v_mfma_f32_32x32x16_bf16 v[16:31], v[116:119], v[84:87], v[16:31]
  v_exp_f32 v36, v36
  v_exp_f32 v37, v37
  v_exp_f32 v38, v38
  v_exp_f32 v39, v39
  v_cvt_pk_bf16_f32 v56, v32, v33
  v_cvt_pk_bf16_f32 v57, v34, v35
  v_mfma_f32_32x32x16_bf16 v[160:175], v[120:123], v[48:51], v[160:175]
  v_exp_f32 v40, v40
  v_exp_f32 v41, v41
  v_exp_f32 v42, v42
  v_exp_f32 v43, v43
  v_cvt_pk_bf16_f32 v58, v36, v37
  v_cvt_pk_bf16_f32 v59, v38, v39
  v_mfma_f32_32x32x16_bf16 v[160:175], v[124:127], v[52:55], v[160:175]
  v_exp_f32 v44, v44
  v_exp_f32 v45, v45
  v_exp_f32 v46, v46
  v_exp_f32 v47, v47
  v_cvt_pk_bf16_f32 v60, v40, v41
  v_cvt_pk_bf16_f32 v61, v42, v43
  v_cvt_pk_bf16_f32 v62, v44, v45
  v_cvt_pk_bf16_f32 v63, v46, v47
  buffer_load_dwordx4 v[96:99], v248, s[48:51], s52 offen offset:0
  buffer_load_dwordx4 v[100:103], v248, s[48:51], s52 offen offset:1024
  buffer_load_dwordx4 v[104:107], v249, s[48:51], s52 offen offset:0
  buffer_load_dwordx4 v[108:111], v249, s[48:51], s52 offen offset:1024
  s_add_u32 s52, s52, 6144
  v_mfma_f32_32x32x16_bf16 v[32:47], v[112:115], v[88:91], 0
  v_exp_f32 v16, v16
  v_exp_f32 v17, v17
  v_exp_f32 v18, v18
  v_exp_f32 v19, v19
  v_mfma_f32_32x32x16_bf16 v[32:47], v[116:119], v[92:95], v[32:47]
  v_exp_f32 v20, v20
  v_exp_f32 v21, v21
  v_exp_f32 v22, v22
  v_exp_f32 v23, v23
  v_cvt_pk_bf16_f32 v48, v16, v17
  v_cvt_pk_bf16_f32 v49, v18, v19
  v_mfma_f32_32x32x16_bf16 v[176:191], v[120:123], v[56:59], v[176:191]
  v_exp_f32 v24, v24
  v_exp_f32 v25, v25
  v_exp_f32 v26, v26
  v_exp_f32 v27, v27
  v_cvt_pk_bf16_f32 v50, v20, v21
  v_cvt_pk_bf16_f32 v51, v22, v23
  v_mfma_f32_32x32x16_bf16 v[176:191], v[124:127], v[60:63], v[176:191]
  v_exp_f32 v28, v28
  v_exp_f32 v29, v29
  v_exp_f32 v30, v30
  v_exp_f32 v31, v31
  v_cvt_pk_bf16_f32 v52, v24, v25
  v_cvt_pk_bf16_f32 v53, v26, v27
  v_cvt_pk_bf16_f32 v54, v28, v29
  v_cvt_pk_bf16_f32 v55, v30, v31
  s_waitcnt vmcnt(10)
  v_mfma_f32_32x32x16_bf16 v[16:31], v[128:131], v[64:67], 0
  v_exp_f32 v32, v32
  v_exp_f32 v33, v33
  v_exp_f32 v34, v34
  v_exp_f32 v35, v35
  v_mfma_f32_32x32x16_bf16 v[16:31], v[132:135], v[68:71], v[16:31]
  v_exp_f32 v36, v36
  v_exp_f32 v37, v37
  v_exp_f32 v38, v38
  v_exp_f32 v39, v39
  v_cvt_pk_bf16_f32 v56, v32, v33
  v_cvt_pk_bf16_f32 v57, v34, v35
  v_mfma_f32_32x32x16_bf16 v[192:207], v[120:123], v[48:51], v[192:207]
  v_exp_f32 v40, v40
  v_exp_f32 v41, v41
  v_exp_f32 v42, v42
  v_exp_f32 v43, v43
  v_cvt_pk_bf16_f32 v58, v36, v37
  v_cvt_pk_bf16_f32 v59, v38, v39
  v_mfma_f32_32x32x16_bf16 v[192:207], v[124:127], v[52:55], v[192:207]
  v_exp_f32 v44, v44
  v_exp_f32 v45, v45
  v_exp_f32 v46, v46
  v_exp_f32 v47, v47
  v_cvt_pk_bf16_f32 v60, v40, v41
  v_cvt_pk_bf16_f32 v61, v42, v43
  v_cvt_pk_bf16_f32 v62, v44, v45
  v_cvt_pk_bf16_f32 v63, v46, v47
  v_mfma_f32_32x32x16_bf16 v[32:47], v[128:131], v[72:75], 0
  v_exp_f32 v16, v16
  v_exp_f32 v17, v17
  v_exp_f32 v18, v18
  v_exp_f32 v19, v19
  v_mfma_f32_32x32x16_bf16 v[32:47], v[132:135], v[76:79], v[32:47]
  v_exp_f32 v20, v20
  v_exp_f32 v21, v21
  v_exp_f32 v22, v22
  v_exp_f32 v23, v23
  v_cvt_pk_bf16_f32 v48, v16, v17
  v_cvt_pk_bf16_f32 v49, v18, v19
  v_mfma_f32_32x32x16_bf16 v[208:223], v[120:123], v[56:59], v[208:223]
  v_exp_f32 v24, v24
  v_exp_f32 v25, v25
  v_exp_f32 v26, v26
  v_exp_f32 v27, v27
  v_cvt_pk_bf16_f32 v50, v20, v21
  v_cvt_pk_bf16_f32 v51, v22, v23
  v_mfma_f32_32x32x16_bf16 v[208:223], v[124:127], v[60:63], v[208:223]
  v_exp_f32 v28, v28
  v_exp_f32 v29, v29
  v_exp_f32 v30, v30
  v_exp_f32 v31, v31
  v_cvt_pk_bf16_f32 v52, v24, v25
  v_cvt_pk_bf16_f32 v53, v26, v27
  v_cvt_pk_bf16_f32 v54, v28, v29
  v_cvt_pk_bf16_f32 v55, v30, v31
  s_waitcnt vmcnt(8)
  v_mfma_f32_32x32x16_bf16 v[16:31], v[128:131], v[80:83], 0
  v_exp_f32 v32, v32
  v_exp_f32 v33, v33
  v_exp_f32 v34, v34
  v_exp_f32 v35, v35
  v_mfma_f32_32x32x16_bf16 v[16:31], v[132:135], v[84:87], v[16:31]
  v_exp_f32 v36, v36
  v_exp_f32 v37, v37
  v_exp_f32 v38, v38
  v_exp_f32 v39, v39
  v_cvt_pk_bf16_f32 v56, v32, v33
  v_cvt_pk_bf16_f32 v57, v34, v35
  v_mfma_f32_32x32x16_bf16 v[160:175], v[136:139], v[48:51], v[160:175]
  v_exp_f32 v40, v40
  v_exp_f32 v41, v41
  v_exp_f32 v42, v42
  v_exp_f32 v43, v43
  v_cvt_pk_bf16_f32 v58, v36, v37
  v_cvt_pk_bf16_f32 v59, v38, v39
  v_mfma_f32_32x32x16_bf16 v[160:175], v[140:143], v[52:55], v[160:175]
  v_exp_f32 v44, v44
  v_exp_f32 v45, v45
  v_exp_f32 v46, v46
  v_exp_f32 v47, v47
  v_cvt_pk_bf16_f32 v60, v40, v41
  v_cvt_pk_bf16_f32 v61, v42, v43
  v_cvt_pk_bf16_f32 v62, v44, v45
  v_cvt_pk_bf16_f32 v63, v46, v47
  buffer_load_dwordx4 v[112:115], v248, s[48:51], s52 offen offset:0
  buffer_load_dwordx4 v[116:119], v248, s[48:51], s52 offen offset:1024
  buffer_load_dwordx4 v[120:123], v249, s[48:51], s52 offen offset:0
  buffer_load_dwordx4 v[124:127], v249, s[48:51], s52 offen offset:1024
  s_add_u32 s52, s52, 6144
  v_mfma_f32_32x32x16_bf16 v[32:47], v[128:131], v[88:91], 0
  v_exp_f32 v16, v16
  v_exp_f32 v17, v17
  v_exp_f32 v18, v18
  v_exp_f32 v19, v19
  v_mfma_f32_32x32x16_bf16 v[32:47], v[132:135], v[92:95], v[32:47]
  v_exp_f32 v20, v20
  v_exp_f32 v21, v21
  v_exp_f32 v22, v22
  v_exp_f32 v23, v23
  v_cvt_pk_bf16_f32 v48, v16, v17
  v_cvt_pk_bf16_f32 v49, v18, v19
  v_mfma_f32_32x32x16_bf16 v[176:191], v[136:139], v[56:59], v[176:191]
  v_exp_f32 v24, v24
  v_exp_f32 v25, v25
  v_exp_f32 v26, v26
  v_exp_f32 v27, v27
  v_cvt_pk_bf16_f32 v50, v20, v21
  v_cvt_pk_bf16_f32 v51, v22, v23
  v_mfma_f32_32x32x16_bf16 v[176:191], v[140:143], v[60:63], v[176:191]
  v_exp_f32 v28, v28
  v_exp_f32 v29, v29
  v_exp_f32 v30, v30
  v_exp_f32 v31, v31
  v_cvt_pk_bf16_f32 v52, v24, v25
  v_cvt_pk_bf16_f32 v53, v26, v27
  v_cvt_pk_bf16_f32 v54, v28, v29
  v_cvt_pk_bf16_f32 v55, v30, v31
  s_waitcnt vmcnt(10)
  v_mfma_f32_32x32x16_bf16 v[16:31], v[144:147], v[64:67], 0
  v_exp_f32 v32, v32
  v_exp_f32 v33, v33
  v_exp_f32 v34, v34
  v_exp_f32 v35, v35
  v_mfma_f32_32x32x16_bf16 v[16:31], v[148:151], v[68:71], v[16:31]
  v_exp_f32 v36, v36
  v_exp_f32 v37, v37
  v_exp_f32 v38, v38
  v_exp_f32 v39, v39
  v_cvt_pk_bf16_f32 v56, v32, v33
  v_cvt_pk_bf16_f32 v57, v34, v35
  v_mfma_f32_32x32x16_bf16 v[192:207], v[136:139], v[48:51], v[192:207]
  v_exp_f32 v40, v40
  v_exp_f32 v41, v41
  v_exp_f32 v42, v42
  v_exp_f32 v43, v43
  v_cvt_pk_bf16_f32 v58, v36, v37
  v_cvt_pk_bf16_f32 v59, v38, v39
  v_mfma_f32_32x32x16_bf16 v[192:207], v[140:143], v[52:55], v[192:207]
  v_exp_f32 v44, v44
  v_exp_f32 v45, v45
  v_exp_f32 v46, v46
  v_exp_f32 v47, v47
  v_cvt_pk_bf16_f32 v60, v40, v41
  v_cvt_pk_bf16_f32 v61, v42, v43
  v_cvt_pk_bf16_f32 v62, v44, v45
  v_cvt_pk_bf16_f32 v63, v46, v47
  v_mfma_f32_32x32x16_bf16 v[32:47], v[144:147], v[72:75], 0
  v_exp_f32 v16, v16
  v_exp_f32 v17, v17
  v_exp_f32 v18, v18
  v_exp_f32 v19, v19
  v_mfma_f32_32x32x16_bf16 v[32:47], v[148:151], v[76:79], v[32:47]
  v_exp_f32 v20, v20
  v_exp_f32 v21, v21
  v_exp_f32 v22, v22
  v_exp_f32 v23, v23
  v_cvt_pk_bf16_f32 v48, v16, v17
  v_cvt_pk_bf16_f32 v49, v18, v19
  v_mfma_f32_32x32x16_bf16 v[208:223], v[136:139], v[56:59], v[208:223]
  v_exp_f32 v24, v24
  v_exp_f32 v25, v25
  v_exp_f32 v26, v26
  v_exp_f32 v27, v27
  v_cvt_pk_bf16_f32 v50, v20, v21
  v_cvt_pk_bf16_f32 v51, v22, v23
  v_mfma_f32_32x32x16_bf16 v[208:223], v[140:143], v[60:63], v[208:223]
  v_exp_f32 v28, v28
  v_exp_f32 v29, v29
  v_exp_f32 v30, v30
  v_exp_f32 v31, v31
  v_cvt_pk_bf16_f32 v52, v24, v25
  v_cvt_pk_bf16_f32 v53, v26, v27
  v_cvt_pk_bf16_f32 v54, v28, v29
  v_cvt_pk_bf16_f32 v55, v30, v31
  s_waitcnt vmcnt(8)
  v_mfma_f32_32x32x16_bf16 v[16:31], v[144:147], v[80:83], 0
  v_exp_f32 v32, v32
  v_exp_f32 v33, v33
  v_exp_f32 v34, v34
  v_exp_f32 v35, v35
  v_mfma_f32_32x32x16_bf16 v[16:31], v[148:151], v[84:87], v[16:31]
  v_exp_f32 v36, v36
  v_exp_f32 v37, v37
  v_exp_f32 v38, v38
  v_exp_f32 v39, v39
  v_cvt_pk_bf16_f32 v56, v32, v33
  v_cvt_pk_bf16_f32 v57, v34, v35
  v_mfma_f32_32x32x16_bf16 v[160:175], v[152:155], v[48:51], v[160:175]
  v_exp_f32 v40, v40
  v_exp_f32 v41, v41
  v_exp_f32 v42, v42
  v_exp_f32 v43, v43
  v_cvt_pk_bf16_f32 v58, v36, v37
  v_cvt_pk_bf16_f32 v59, v38, v39
  v_mfma_f32_32x32x16_bf16 v[160:175], v[156:159], v[52:55], v[160:175]
  v_exp_f32 v44, v44
  v_exp_f32 v45, v45
  v_exp_f32 v46, v46
  v_exp_f32 v47, v47
  v_cvt_pk_bf16_f32 v60, v40, v41
  v_cvt_pk_bf16_f32 v61, v42, v43
  v_cvt_pk_bf16_f32 v62, v44, v45
  v_cvt_pk_bf16_f32 v63, v46, v47
  buffer_load_dwordx4 v[128:131], v248, s[48:51], s52 offen offset:0
  buffer_load_dwordx4 v[132:135], v248, s[48:51], s52 offen offset:1024
  buffer_load_dwordx4 v[136:139], v249, s[48:51], s52 offen offset:0
  buffer_load_dwordx4 v[140:143], v249, s[48:51], s52 offen offset:1024
  s_add_u32 s52, s52, 6144
  v_mfma_f32_32x32x16_bf16 v[32:47], v[144:147], v[88:91], 0
  v_exp_f32 v16, v16
  v_exp_f32 v17, v17
  v_exp_f32 v18, v18
  v_exp_f32 v19, v19
  v_mfma_f32_32x32x16_bf16 v[32:47], v[148:151], v[92:95], v[32:47]
  v_exp_f32 v20, v20
  v_exp_f32 v21, v21
  v_exp_f32 v22, v22
  v_exp_f32 v23, v23
  v_cvt_pk_bf16_f32 v48, v16, v17
  v_cvt_pk_bf16_f32 v49, v18, v19
  v_mfma_f32_32x32x16_bf16 v[176:191], v[152:155], v[56:59], v[176:191]
  v_exp_f32 v24, v24
  v_exp_f32 v25, v25
  v_exp_f32 v26, v26
  v_exp_f32 v27, v27
  v_cvt_pk_bf16_f32 v50, v20, v21
  v_cvt_pk_bf16_f32 v51, v22, v23
  v_mfma_f32_32x32x16_bf16 v[176:191], v[156:159], v[60:63], v[176:191]
  v_exp_f32 v28, v28
  v_exp_f32 v29, v29
  v_exp_f32 v30, v30
  v_exp_f32 v31, v31
  v_cvt_pk_bf16_f32 v52, v24, v25
  v_cvt_pk_bf16_f32 v53, v26, v27
  v_cvt_pk_bf16_f32 v54, v28, v29
  v_cvt_pk_bf16_f32 v55, v30, v31
  s_waitcnt vmcnt(10)
  v_mfma_f32_32x32x16_bf16 v[16:31], v[96:99], v[64:67], 0
  v_exp_f32 v32, v32
  v_exp_f32 v33, v33
  v_exp_f32 v34, v34
  v_exp_f32 v35, v35
  v_mfma_f32_32x32x16_bf16 v[16:31], v[100:103], v[68:71], v[16:31]
  v_exp_f32 v36, v36
  v_exp_f32 v37, v37
  v_exp_f32 v38, v38
  v_exp_f32 v39, v39
  v_cvt_pk_bf16_f32 v56, v32, v33
  v_cvt_pk_bf16_f32 v57, v34, v35
  v_mfma_f32_32x32x16_bf16 v[192:207], v[152:155], v[48:51], v[192:207]
  v_exp_f32 v40, v40
  v_exp_f32 v41, v41
  v_exp_f32 v42, v42
  v_exp_f32 v43, v43
  v_cvt_pk_bf16_f32 v58, v36, v37
  v_cvt_pk_bf16_f32 v59, v38, v39
  v_mfma_f32_32x32x16_bf16 v[192:207], v[156:159], v[52:55], v[192:207]
  v_exp_f32 v44, v44
  v_exp_f32 v45, v45
  v_exp_f32 v46, v46
  v_exp_f32 v47, v47
  v_cvt_pk_bf16_f32 v60, v40, v41
  v_cvt_pk_bf16_f32 v61, v42, v43
  v_cvt_pk_bf16_f32 v62, v44, v45
  v_cvt_pk_bf16_f32 v63, v46, v47
  s_sub_u32 s53, s53, 1
  s_cmp_lg_u32 s53, 0
  s_cbranch_scc1 L_at_main
  v_mfma_f32_32x32x16_bf16 v[208:223], v[152:155], v[56:59], v[208:223]
  v_mfma_f32_32x32x16_bf16 v[208:223], v[156:159], v[60:63], v[208:223]
  s_nop 10
  s_mov_b32 exec_lo, 0
  v_mov_b32 v189, v13
  v_mov_b32 v205, v14
  v_mov_b32 v221, v15
  s_mov_b64 exec, -1
  v_lshlrev_b32 v4, 4, v1
  s_xor_b32 s55, s30, 1
  s_mul_i32 s55, s55, 12288
  s_add_u32 s55, s55, 114688
  v_add_u32 v5, s55, v4
  ds_write_b128 v5, v[176:179] offset:0
  ds_write_b128 v5, v[180:183] offset:1024
  ds_write_b128 v5, v[184:187] offset:2048
  ds_write_b64 v5, v[188:189] offset:3072
  s_mov_b32 exec_hi, 0
  ds_write_b64 v5, v[190:191] offset:3080
  s_mov_b64 exec, -1
  s_xor_b32 s55, s30, 2
  s_mul_i32 s55, s55, 12288
  s_add_u32 s55, s55, 118784
  v_add_u32 v5, s55, v4
  ds_write_b128 v5, v[192:195] offset:0
  ds_write_b128 v5, v[196:199] offset:1024
  ds_write_b128 v5, v[200:203] offset:2048
  ds_write_b64 v5, v[204:205] offset:3072
  s_mov_b32 exec_hi, 0
  ds_write_b64 v5, v[206:207] offset:3080
  s_mov_b64 exec, -1
  s_xor_b32 s55, s30, 3
  s_mul_i32 s55, s55, 12288
  s_add_u32 s55, s55, 122880
  v_add_u32 v5, s55, v4
  ds_write_b128 v5, v[208:211] offset:0
  ds_write_b128 v5, v[212:215] offset:1024
  ds_write_b128 v5, v[216:219] offset:2048
  ds_write_b64 v5, v[220:221] offset:3072
  s_mov_b32 exec_hi, 0
  ds_write_b64 v5, v[222:223] offset:3080
  s_mov_b64 exec, -1
  v_add_f32 v16, v160, v164
  v_add_f32 v17, v161, v165
  v_add_f32 v18, v162, v166
  v_add_f32 v19, v163, v167
  v_add_f32 v16, v16, v168
  v_add_f32 v17, v17, v169
  v_add_f32 v18, v18, v170
  v_add_f32 v19, v19, v171
  v_add_f32 v16, v16, v172
  v_add_f32 v17, v17, v173
  v_add_f32 v18, v18, v174
  v_add_f32 v19, v19, v175
  v_add_f32 v16, v16, v176
  v_add_f32 v17, v17, v177
  v_add_f32 v18, v18, v178
  v_add_f32 v19, v19, v179
  v_add_f32 v16, v16, v180
  v_add_f32 v17, v17, v181
  v_add_f32 v18, v18, v182
  v_add_f32 v19, v19, v183
  v_add_f32 v16, v16, v184
  v_add_f32 v17, v17, v185
  v_add_f32 v18, v18, v186
  v_add_f32 v19, v19, v187
  v_add_f32 v16, v16, v188
  v_add_f32 v17, v17, v189
  v_add_f32 v18, v18, v190
  v_add_f32 v19, v19, v191
  v_add_f32 v16, v16, v192
  v_add_f32 v17, v17, v193
  v_add_f32 v18, v18, v194
  v_add_f32 v19, v19, v195
  v_add_f32 v16, v16, v196
  v_add_f32 v17, v17, v197
  v_add_f32 v18, v18, v198
  v_add_f32 v19, v19, v199
  v_add_f32 v16, v16, v200
  v_add_f32 v17, v17, v201
  v_add_f32 v18, v18, v202
  v_add_f32 v19, v19, v203
  v_add_f32 v16, v16, v204
  v_add_f32 v17, v17, v205
  v_add_f32 v18, v18, v206
  v_add_f32 v19, v19, v207
  v_add_f32 v16, v16, v208
  v_add_f32 v17, v17, v209
  v_add_f32 v18, v18, v210
  v_add_f32 v19, v19, v211
  v_add_f32 v16, v16, v212
  v_add_f32 v17, v17, v213
  v_add_f32 v18, v18, v214
  v_add_f32 v19, v19, v215
  v_add_f32 v16, v16, v216
  v_add_f32 v17, v17, v217
  v_add_f32 v18, v18, v218
  v_add_f32 v19, v19, v219
  v_add_f32 v16, v16, v220
  v_add_f32 v17, v17, v221
  v_add_f32 v18, v18, v222
  v_add_f32 v19, v19, v223
  v_add_f32 v16, v16, v17
  v_add_f32 v18, v18, v19
  v_add_f32 v16, v16, v18
  v_mov_b32 v17, 0x207
  v_cmp_class_f32 vcc, v16, v17
  s_cmp_lg_u32 s54, 0
  s_cbranch_scc1 L_at_reduce
  s_cbranch_vccz L_at_reduce
  s_mov_b32 s54, 1
  s_waitcnt vmcnt(0)
  s_mov_b64 exec, s[58:59]
  s_cmp_eq_u32 s57, 0
  s_cbranch_scc0 L_at_padodd2
  v_mov_b32 v70, 0
  v_mov_b32 v71, 0
  v_mov_b32 v78, 0
  v_mov_b32 v79, 0
  v_mov_b32 v86, 0
  v_mov_b32 v87, 0
  v_mov_b32 v94, 0
  v_mov_b32 v95, 0
  s_branch L_at_paddone2
L_at_padodd2:
  v_mov_b32 v64, 0
  v_mov_b32 v65, 0
  v_mov_b32 v72, 0
  v_mov_b32 v73, 0
  v_mov_b32 v80, 0
  v_mov_b32 v81, 0
  v_mov_b32 v88, 0
  v_mov_b32 v89, 0
L_at_paddone2:
  s_mov_b64 exec, -1
  v_mov_b32 v12, 0xff800000
  v_mov_b32 v13, 0xff800000
  v_mov_b32 v14, 0xff800000
  v_mov_b32 v15, 0xff800000
  s_mov_b32 s52, 0
  s_mov_b32 s53, 16
L_at_slow:
  buffer_load_dwordx4 v[96:99], v248, s[48:51], s52 offen offset:0
  buffer_load_dwordx4 v[100:103], v248, s[48:51], s52 offen offset:1024
  s_add_u32 s52, s52, 6144
  s_waitcnt vmcnt(0)
  v_mfma_f32_32x32x16_bf16 v[16:31], v[96:99], v[64:67], 0
  v_mfma_f32_32x32x16_bf16 v[16:31], v[100:103], v[68:71], v[16:31]
  s_nop 15
  v_max3_f32 v12, v12, v16, v17
  v_max3_f32 v12, v12, v18, v19
  v_max3_f32 v12, v12, v20, v21
  v_max3_f32 v12, v12, v22, v23
  v_max3_f32 v12, v12, v24, v25
  v_max3_f32 v12, v12, v26, v27
  v_max3_f32 v12, v12, v28, v29
  v_max3_f32 v12, v12, v30, v31
  v_mfma_f32_32x32x16_bf16 v[16:31], v[96:99], v[72:75], 0
  v_mfma_f32_32x32x16_bf16 v[16:31], v[100:103], v[76:79], v[16:31]
  s_nop 15
  v_max3_f32 v13, v13, v16, v17
  v_max3_f32 v13, v13, v18, v19
  v_max3_f32 v13, v13, v20, v21
  v_max3_f32 v13, v13, v22, v23
  v_max3_f32 v13, v13, v24, v25
  v_max3_f32 v13, v13, v26, v27
  v_max3_f32 v13, v13, v28, v29
  v_max3_f32 v13, v13, v30, v31
  v_mfma_f32_32x32x16_bf16 v[16:31], v[96:99], v[80:83], 0
  v_mfma_f32_32x32x16_bf16 v[16:31], v[100:103], v[84:87], v[16:31]
  s_nop 15
  v_max3_f32 v14, v14, v16, v17
  v_max3_f32 v14, v14, v18, v19
  v_max3_f32 v14, v14, v20, v21
  v_max3_f32 v14, v14, v22, v23
  v_max3_f32 v14, v14, v24, v25
  v_max3_f32 v14, v14, v26, v27
  v_max3_f32 v14, v14, v28, v29
  v_max3_f32 v14, v14, v30, v31
  v_mfma_f32_32x32x16_bf16 v[16:31], v[96:99], v[88:91], 0
  v_mfma_f32_32x32x16_bf16 v[16:31], v[100:103], v[92:95], v[16:31]
  s_nop 15
  v_max3_f32 v15, v15, v16, v17
  v_max3_f32 v15, v15, v18, v19
  v_max3_f32 v15, v15, v20, v21
  v_max3_f32 v15, v15, v22, v23
  v_max3_f32 v15, v15, v24, v25
  v_max3_f32 v15, v15, v26, v27
  v_max3_f32 v15, v15, v28, v29
  v_max3_f32 v15, v15, v30, v31
  s_sub_u32 s53, s53, 1
  s_cmp_lg_u32 s53, 0
  s_cbranch_scc1 L_at_slow
  s_mov_b32 s52, 0
  buffer_load_dwordx4 v[96:99], v248, s[48:51], s52 offen offset:0
  buffer_load_dwordx4 v[100:103], v248, s[48:51], s52 offen offset:1024
  buffer_load_dwordx4 v[104:107], v249, s[48:51], s52 offen offset:0
  buffer_load_dwordx4 v[108:111], v249, s[48:51], s52 offen offset:1024
  s_add_u32 s52, s52, 6144
  buffer_load_dwordx4 v[112:115], v248, s[48:51], s52 offen offset:0
  buffer_load_dwordx4 v[116:119], v248, s[48:51], s52 offen offset:1024
  buffer_load_dwordx4 v[120:123], v249, s[48:51], s52 offen offset:0
  buffer_load_dwordx4 v[124:127], v249, s[48:51], s52 offen offset:1024
  s_add_u32 s52, s52, 6144
  buffer_load_dwordx4 v[128:131], v248, s[48:51], s52 offen offset:0
  buffer_load_dwordx4 v[132:135], v248, s[48:51], s52 offen offset:1024
  buffer_load_dwordx4 v[136:139], v249, s[48:51], s52 offen offset:0
  buffer_load_dwordx4 v[140:143], v249, s[48:51], s52 offen offset:1024
  s_add_u32 s52, s52, 6144
  s_waitcnt vmcnt(10)
  s_branch L_at_setmax
L_at_reduce:
  s_mul_i32 s55, s30, 12288
  s_add_u32 s55, s55, 114688
  v_add_u32 v5, s55, v4
  s_lshr_b32 s55, s61, 1
  s_lshl_b32 s55, s55, 3
  s_lshl_b32 s56, s30, 1
  s_add_u32 s55, s55, s56
  s_add_u32 s55, s55, s57
  s_lshl_b32 s55, s55, 11
  s_lshl_b32 s56, s60, 15
  s_add_u32 s55, s55, s56
  s_add_u32 s55, s55, 11534336
  v_and_b32 v4, 31, v1
  v_lshlrev_b32 v4, 4, v4
  v_lshrrev_b32 v6, 5, v1
  v_lshl_add_u32 v4, v6, 10, v4
  v_add_u32 v4, s55, v4
  s_lshl_b32 s55, s2, 2
  s_add_u32 s55, s55, s30
  s_lshl_b32 s55, s55, 2
  s_add_u32 s55, s55, 2695168
  s_lshl_b32 s56, s30, 4
  s_add_u32 s56, s56, 118280
  v_mov_b32 v8, s56
  v_mov_b32 v9, s35
  v_and_b32 v10, 3, v1
  v_lshlrev_b32 v10, 4, v10
  v_add_u32 v10, 118280, v10
  s_waitcnt lgkmcnt(0)
  ds_write_b32 v8, v9
  s_mov_b32 s53, 3200000
L_at_sync:
  ds_read_b32 v11, v10
  s_waitcnt lgkmcnt(0)
  v_cmp_ne_u32 vcc, v11, v9
  s_sub_u32 s53, s53, 1
  s_cmp_eq_u32 s53, 0
  s_cbranch_scc1 L_at_synced
  s_cbranch_vccnz L_at_sync
L_at_synced:
  ds_read_b128 v[188:191], v5 offset:3072
  ds_read_b128 v[176:179], v5 offset:0
  ds_read_b128 v[180:183], v5 offset:1024
  ds_read_b128 v[184:187], v5 offset:2048
  ds_read_b128 v[204:207], v5 offset:7168
  ds_read_b128 v[192:195], v5 offset:4096
  ds_read_b128 v[196:199], v5 offset:5120
  ds_read_b128 v[200:203], v5 offset:6144
  ds_read_b128 v[220:223], v5 offset:11264
  ds_read_b128 v[208:211], v5 offset:8192
  ds_read_b128 v[212:215], v5 offset:9216
  ds_read_b128 v[216:219], v5 offset:10240
  s_waitcnt lgkmcnt(3)
  v_mov_b32 v13, v189
  v_mov_b32 v9, v189
  v_mov_b32 v14, v205
  v_mov_b32 v10, v205
  v_mov_b32 v15, v221
  v_mov_b32 v11, v221
  s_nop 1
  v_permlane32_swap_b32 v9, v13
  v_permlane32_swap_b32 v10, v14
  v_permlane32_swap_b32 v11, v15
  s_nop 1
  v_max3_f32 v8, v12, v13, v14
  v_max_f32 v8, v8, v15
  v_sub_f32 v12, v12, v8
  v_sub_f32 v13, v13, v8
  v_sub_f32 v14, v14, v8
  v_sub_f32 v15, v15, v8
  v_exp_f32 v12, v12
  v_exp_f32 v13, v13
  v_exp_f32 v14, v14
  v_exp_f32 v15, v15
  s_nop 0
  v_mul_f32 v8, v172, v12
  v_fmac_f32 v8, v188, v13
  v_fmac_f32 v8, v204, v14
  v_fmac_f32 v8, v220, v15
  v_mov_b32 v9, v8
  s_nop 1
  v_permlane32_swap_b32 v8, v9
  s_nop 1
  v_rcp_f32 v9, v9
  v_cmp_eq_u32 vcc, 1, v6
  v_mul_f32 v12, v12, v9
  v_mul_f32 v13, v13, v9
  v_mul_f32 v14, v14, v9
  v_mul_f32 v15, v15, v9
  v_mul_f32 v160, v160, v12
  v_mul_f32 v161, v161, v12
  v_mul_f32 v162, v162, v12
  v_mul_f32 v163, v163, v12
  v_mul_f32 v164, v164, v12
  v_mul_f32 v165, v165, v12
  v_mul_f32 v166, v166, v12
  v_mul_f32 v167, v167, v12
  v_mul_f32 v168, v168, v12
  v_mul_f32 v169, v169, v12
  v_mul_f32 v170, v170, v12
  v_mul_f32 v171, v171, v12
  v_mul_f32 v172, v172, v12
  v_mul_f32 v173, v173, v12
  v_mul_f32 v174, v174, v12
  v_mul_f32 v175, v175, v12
  s_waitcnt lgkmcnt(0)
  v_fmac_f32 v160, v176, v13
  v_fmac_f32 v161, v177, v13
  v_fmac_f32 v162, v178, v13
  v_fmac_f32 v163, v179, v13
  v_fmac_f32 v164, v180, v13
  v_fmac_f32 v165, v181, v13
  v_fmac_f32 v166, v182, v13
  v_fmac_f32 v167, v183, v13
  v_fmac_f32 v168, v184, v13
  v_fmac_f32 v169, v185, v13
  v_fmac_f32 v170, v186, v13
  v_fmac_f32 v171, v187, v13
  v_fmac_f32 v172, v188, v13
  v_fmac_f32 v173, v189, v13
  v_fmac_f32 v174, v190, v13
  v_fmac_f32 v175, v191, v13
  v_fmac_f32 v160, v192, v14
  v_fmac_f32 v161, v193, v14
  v_fmac_f32 v162, v194, v14
  v_fmac_f32 v163, v195, v14
  v_fmac_f32 v164, v196, v14
  v_fmac_f32 v165, v197, v14
  v_fmac_f32 v166, v198, v14
  v_fmac_f32 v167, v199, v14
  v_fmac_f32 v168, v200, v14
  v_fmac_f32 v169, v201, v14
  v_fmac_f32 v170, v202, v14
  v_fmac_f32 v171, v203, v14
  v_fmac_f32 v172, v204, v14
  v_fmac_f32 v173, v205, v14
  v_fmac_f32 v174, v206, v14
  v_fmac_f32 v175, v207, v14
  v_fmac_f32 v160, v208, v15
  v_fmac_f32 v161, v209, v15
  v_fmac_f32 v162, v210, v15
  v_fmac_f32 v163, v211, v15
  v_fmac_f32 v164, v212, v15
  v_fmac_f32 v165, v213, v15
  v_fmac_f32 v166, v214, v15
  v_fmac_f32 v167, v215, v15
  v_fmac_f32 v168, v216, v15
  v_fmac_f32 v169, v217, v15
  v_fmac_f32 v170, v218, v15
  v_fmac_f32 v171, v219, v15
  v_fmac_f32 v172, v220, v15
  v_fmac_f32 v173, v221, v15
  v_fmac_f32 v174, v222, v15
  v_fmac_f32 v175, v223, v15
  v_cvt_pk_bf16_f32 v16, v160, v161
  v_cvt_pk_bf16_f32 v17, v162, v163
  v_cvt_pk_bf16_f32 v18, v164, v165
  v_cvt_pk_bf16_f32 v19, v166, v167
  v_cvt_pk_bf16_f32 v20, v168, v169
  v_cvt_pk_bf16_f32 v21, v170, v171
  v_cvt_pk_bf16_f32 v22, v172, v173
  v_cvt_pk_bf16_f32 v23, v174, v175
  v_mov_b32 v8, 0
  v_cndmask_b32 v22, v22, v8, vcc
  v_cndmask_b32 v23, v23, v8, vcc
  global_store_dwordx4 v4, v[16:19], s[26:27] sc1
  global_store_dwordx4 v4, v[20:23], s[26:27] offset:512 sc1
  s_waitcnt vmcnt(0)
  v_mov_b32 v8, s55
  v_mov_b32 v9, s35
  s_mov_b64 exec, 1
  global_store_dword v8, v9, s[26:27] sc1
  s_mov_b64 exec, -1
  s_endpgm
L_last:
  s_endpgm
.section .rodata,"a"
.p2align 6
.amdhsa_kernel recurrent_scan__grouped_kv_mqa__glu_gated_reglu__prompt_kernel
  .amdhsa_next_free_vgpr 256
  .amdhsa_next_free_sgpr 102
  .amdhsa_accum_offset 256
  .amdhsa_group_segment_fixed_size 0
  .amdhsa_kernarg_size 96
  .amdhsa_user_sgpr_count 2
  .amdhsa_user_sgpr_kernarg_segment_ptr 1
  .amdhsa_system_sgpr_workgroup_id_x 1
.end_amdhsa_kernel
```
